```python
import torch

def _softmax(x, axis=-1):
    return torch.softmax(x, dim=axis)
def _gelu(x):
    return torch.nn.functional.gelu(x, approximate="tanh")
def _silu(x):
    return torch.nn.functional.silu(x)
def _sigmoid(x):
    return torch.sigmoid(x)
def _layernorm(x, axis=-1, eps=1e-5):
    m = x.mean(dim=axis, keepdim=True)
    v = x.var(dim=axis, keepdim=True, unbiased=False)
    return (x - m) / torch.sqrt(v + eps)
def _scatter_add(tgt, idx, src, axis=0):
    return tgt.clone().index_add_(axis, idx, src)
def _segment_sum(src, seg, n):
    out = torch.zeros((n,) + src.shape[1:], dtype=src.dtype)
    return out.index_add_(0, seg, src)
def _pad(x, pw):
    flat = tuple(v for pair in reversed(pw) for v in pair)
    return torch.nn.functional.pad(x, flat)

kernel_name = 'gated_mix__ssm_conv_s4d__glu_gated_swiglu__prompt'

def setup_inputs():

    _w = (lambda a: (lambda t: t.to(torch.bfloat16) if t.is_floating_point() else t)(torch.as_tensor(a)))
    def _A_setup():
        Bsz, L, D, N = 1, 2048, 512, 128
        return {
            "u": _w((lambda *s: torch.randn(*s, dtype=torch.bfloat16) * 0.05)(Bsz, L, D)),
            "log_A_real": _w((lambda *s: torch.randn(*s, dtype=torch.bfloat16) * 3.2)(D, N) * 0.5),
            "A_imag": _w((lambda *s: torch.randn(*s, dtype=torch.bfloat16) * 0.05)(D, N) * 3.14),
            "C_real": _w((lambda *s: torch.randn(*s, dtype=torch.bfloat16) * 0.05)(D, N) / N ** 0.5),
            "C_imag": _w((lambda *s: torch.randn(*s, dtype=torch.bfloat16) * 0.1)(D, N) / N ** 0.5),
            "log_dt": _w((lambda *s: torch.randn(*s, dtype=torch.bfloat16) * 0.05)(D) * 0.5 - 4.0),
            "D_skip": _w((lambda *s: torch.randn(*s, dtype=torch.bfloat16) * 0.05)(D)),
        }
    _A_in = _A_setup()

    def _B_setup():
        B, S, D, F = 1, 2048, 512, 1792
        return {
            "x": _w((lambda *s: torch.randn(*s, dtype=torch.bfloat16) * 0.05)(B, S, D)),
            "w1": _w((lambda *s: torch.randn(*s, dtype=torch.bfloat16) * 0.8)(D, F) * (2.0 / D) ** 0.5),
            "w3": _w((lambda *s: torch.randn(*s, dtype=torch.bfloat16) * 0.8)(D, F) * (2.0 / D) ** 0.5),
            "w2": _w((lambda *s: torch.randn(*s, dtype=torch.bfloat16) * 0.8)(F, D) * (2.0 / F) ** 0.5),
        }
    _B_in = _B_setup()

    return {
        "A_u": _A_in["u"],
        "A_log_A_real": _A_in["log_A_real"],
        "A_A_imag": _A_in["A_imag"],
        "A_C_real": _A_in["C_real"],
        "A_C_imag": _A_in["C_imag"],
        "A_log_dt": _A_in["log_dt"],
        "A_D_skip": _A_in["D_skip"],
        "B_x": _B_in["x"],
        "B_w1": _B_in["w1"],
        "B_w3": _B_in["w3"],
        "B_w2": _B_in["w2"],
        "gate_w": _w((lambda *s: torch.randn(*s, dtype=torch.bfloat16) * 0.05)(512) * 16.0),
    }

def reference(A_u, A_log_A_real, A_A_imag, A_C_real, A_C_imag, A_log_dt, A_D_skip, B_x, B_w1, B_w3, B_w2, gate_w):
    def _A_ref(u, log_A_real, A_imag, C_real, C_imag, log_dt, D_skip):
        L = u.shape[1]
        dt = torch.exp(log_dt)
        A = -torch.exp(log_A_real) + 1j * A_imag
        C = (C_real + 1j * C_imag) * dt[:, None]
        pos = (lambda x, dt: x.to(dt))(torch.arange(L), log_dt.dtype)
        P = torch.exp((A * dt[:, None])[:, :, None] * pos[None, None, :])
        K = 2.0 * torch.einsum("dn,dnl->dl", C, P).real
        L2 = 2 * L
        u_t = (lambda x, *d: x.permute(*d))(u, 0, 2, 1)
        Kf = (lambda x, *a, **k: torch.fft.rfft(x.float(), *a, **k))(K, L2)
        Uf = (lambda x, *a, **k: torch.fft.rfft(x.float(), *a, **k))(u_t, L2)
        y = (lambda x, *a, **k: torch.fft.irfft(x, *a, **k).to(torch.bfloat16))(Uf * Kf[None, :, :], L2)[:, :, :L]
        y = (lambda x, *d: x.permute(*d))(y, 0, 2, 1)
        return y + u * D_skip[None, None, :]

    def _B_ref(x, w1, w3, w2):
        gate = torch.einsum("bsd,df->bsf", x, w1)
        up = torch.einsum("bsd,df->bsf", x, w3)
        h = _silu(gate) * up
        out = torch.einsum("bsf,fd->bsd", h, w2)
        return out

    x = A_u
    g = _sigmoid((x * gate_w).sum(-1, keepdims=True))
    a = _A_ref(x, A_log_A_real, A_A_imag, A_C_real, A_C_imag, A_log_dt, A_D_skip)
    b = _B_ref(x, B_w1, B_w3, B_w2)
    return g * a + (1 - g) * b
```

```asm
; @launch grid=(256,1,1) block=(256,1,1) lds=163840
.amdgcn_target "amdgcn-amd-amdhsa--gfx950"
.text
.globl gated_mix__ssm_conv_s4d__glu_gated_swiglu__prompt_kernel
.p2align 8
.type gated_mix__ssm_conv_s4d__glu_gated_swiglu__prompt_kernel,@function
gated_mix__ssm_conv_s4d__glu_gated_swiglu__prompt_kernel:
    s_cmp_ge_u32 s2, 256
    s_cbranch_scc1 L_end
    s_load_dwordx16 s[36:51], s[0:1], 0
    s_load_dwordx8 s[52:59], s[0:1], 64
    s_load_dwordx4 s[60:63], s[0:1], 96
    s_load_dwordx2 s[64:65], s[0:1], 112
    s_memrealtime s[76:77]
    s_getpc_b64 s[66:67]
L_pc:
    v_lshrrev_b32 v2, 6, v0
    v_and_b32 v1, 63, v0
    s_lshr_b32 s30, s2, 3
    v_readfirstlane_b32 s24, v2
    v_lshrrev_b32 v3, 5, v0
    v_lshl_add_u32 v3, s30, 3, v3
    v_min_u32 v3, (L_code_end-L_pc)>>7, v3
    v_lshlrev_b32 v3, 7, v3
    global_load_dword a254, v3, s[66:67]
    v_accvgpr_write_b32 a252, v3
    s_and_b32 s31, s2, 1
    s_bfe_u32 s32, s2, 0x20001
    s_and_b32 s28, s24, 1
    s_lshr_b32 s29, s24, 1
    s_and_b32 s87, s2, 7
    s_lshl_b32 s87, s87, 5
    s_add_u32 s87, s87, s30
    s_lshl_b32 s78, s87, 1
    s_add_u32 s78, s78, s29
    s_lshl_b32 s68, s78, 8
    s_lshl_b32 s69, s28, 7
    s_add_u32 s68, s68, s69
    v_lshl_add_u32 v10, v1, 1, s68
    v_mov_b32 v48, 0
    v_mov_b32 v49, 0
    v_mov_b32 v50, 0
    v_mov_b32 v51, 0
    s_lshl_b32 s92, s78, 1
    v_mov_b32 v52, 0
    v_mov_b32 v46, 0
    v_mov_b32 v53, s92
    v_and_b32 v8, 31, v1
    s_lshl_b32 s68, s30, 1
    s_add_u32 s68, s68, s29
    v_mov_b32 v11, v8
    v_lshl_add_u32 v11, s68, 5, v11
    s_movk_i32 s69, 9363
    v_mul_u32_u24 v12, s69, v11
    v_lshrrev_b32 v12, 16, v12
    v_mul_u32_u24 v12, 6272, v12
    v_lshl_add_u32 v11, v11, 7, v12
    s_mul_i32 s91, s32, 896
    s_mul_i32 s68, s31, 3584
    s_add_u32 s91, s91, s68
    s_lshl_b32 s68, s30, 2
    s_add_u32 s68, s68, s24
    s_mul_i32 s68, s68, 20
    v_min_u32 v12, 19, v1
    v_add_u32 v12, s68, v12
    v_min_u32 v12, 2047, v12
    s_nop 0
    s_nop 0
    v_lshlrev_b32 v12, 7, v12
    s_lshl_b32 s90, s31, 2
    s_add_u32 s90, s90, s32
    s_lshl_b32 s90, s90, 18
    v_lshlrev_b32 v38, 4, v1
    v_mov_b32 v40, 0
    v_lshrrev_b32 v3, 4, v1
    v_bfe_u32 v4, v1, 2, 2
    v_and_b32 v5, 3, v1
    v_lshrrev_b32 v6, 3, v1
    v_and_b32 v7, 7, v1
    v_lshrrev_b32 v9, 5, v1
    s_waitcnt lgkmcnt(0)
    global_load_short_d16_hi v48, v10, s[38:39]
    global_load_short_d16_hi v49, v10, s[40:41]
    global_load_short_d16_hi v50, v10, s[42:43]
    global_load_short_d16_hi v51, v10, s[44:45]
    global_load_short_d16_hi v52, v53, s[46:47]
    global_load_short_d16_hi v46, v53, s[48:49]
    s_mov_b32 s4, s36
    s_mov_b32 s5, s37
    s_mov_b32 s6, 0x200000
    s_mov_b32 s7, 0x20000
    s_cmp_eq_u32 s28, 0
    s_cselect_b32 s8, s52, s54
    s_cselect_b32 s9, s53, s55
    s_mov_b32 s10, 1835008
    s_mov_b32 s11, 0x20000
    s_mov_b32 s12, s64
    s_mov_b32 s13, s65
    s_mov_b32 s14, 16777216
    s_mov_b32 s15, 0x20000
    s_mov_b32 s75, 0
    s_cmp_ge_u32 s30, 28
    s_cbranch_scc1 L_helper
    s_barrier
    buffer_load_dword a255, v11, s[8:11], s91 offen
    buffer_load_dword a253, v12, s[4:7], s90 offen
L_hjoin:
    v_mov_b32 v44, v11
    v_mov_b32 v45, v12
    v_mov_b32 v12, 0x40000000
    v_cmp_eq_u32 vcc, 0, v0
    s_mov_b32 s16, s62
    s_mov_b32 s17, s63
    s_mov_b32 s18, 256
    s_mov_b32 s19, 0x20000
    v_cndmask_b32 v14, v12, 0, vcc
    v_cmp_eq_u32 vcc, 0, v1
    s_or_b32 s76, s76, 1
    v_mov_b32 v13, s76
    v_cndmask_b32 v39, v12, 0, vcc
    s_lshl_b32 s68, s2, 10
    buffer_store_dword v13, v14, s[16:19], s68 offen sc1
    s_and_b32 s68, s32, 1
    s_lshl_b32 s68, s68, 2
    s_and_b32 s34, s30, 7
    s_lshr_b32 s69, s30, 3
    s_add_u32 s26, s69, s68
    s_add_u32 s25, s34, s68
    s_cmp_ge_u32 s30, 24
    s_cselect_b32 s26, 3, s26
    s_cselect_b32 s25, s25, s34
    s_lshr_b32 s68, s32, 1
    s_mul_i32 s68, s68, 7
    s_add_u32 s26, s26, s68
    s_lshl_b32 s68, s31, 3
    s_add_u32 s25, s25, s68
    s_mul_i32 s69, s30, 37
    s_lshr_b32 s69, s69, 8
    s_mul_i32 s68, s69, 7
    s_sub_u32 s68, s30, s68
    s_cmp_ge_u32 s68, 3
    s_addc_u32 s34, s68, 0
    s_cmp_ge_u32 s30, 28
    s_cselect_b32 s34, 3, s34
    s_cselect_b32 s69, s68, s69
    s_and_b32 s33, s2, 7
    s_lshl_b32 s33, s33, 2
    s_add_u32 s33, s33, s69
    v_and_b32 v12, 15, v1
    s_lshl_b32 s68, s28, 1
    v_lshl_add_u32 v13, v3, 2, s68
    v_xor_b32 v13, v13, v12
    v_lshlrev_b32 v13, 4, v13
    v_mul_u32_u24 v14, 0xe00, v3
    v_add_u32 v16, v13, v14
    v_add_u32 v17, 13312, v16
    v_add_u32 v18, 26624, v16
    v_add_u32 v19, 39936, v16
    s_lshl_b32 s68, s25, 7
    s_lshl_b32 s69, s24, 5
    s_add_u32 s68, s68, s69
    s_lshl_b32 s68, s68, 10
    s_add_u32 s68, s68, s75
    v_lshrrev_b32 v13, 1, v6
    v_xor_b32 v13, v13, v7
    v_lshlrev_b32 v13, 4, v13
    v_lshl_add_u32 v13, v6, 10, v13
    v_add_u32 v20, s68, v13
    v_xor_b32 v21, 64, v20
    v_add_u32 v21, 7168, v21
    v_add_u32 v22, 14336, v20
    v_add_u32 v23, 14336, v21
    s_lshl_b32 s70, s24, 12
    s_add_u32 s70, s70, 114688
    s_lshl_b32 s71, s28, 14
    s_lshl_b32 s68, s29, 13
    s_add_u32 s71, s71, s68
    s_mul_i32 s72, s29, 114688
    s_lshl_b32 s68, s26, 8
    s_add_u32 s72, s72, s68
    s_add_u32 s72, s72, s75
    s_xor_b32 s27, s25, s26
    s_and_b32 s27, s27, 0
    s_mul_i32 s68, s27, 917504
    s_sub_u32 s3, 917504, s68
    s_add_u32 s3, s3, s72
    s_add_u32 s72, s72, s68
    s_lshl_b32 s27, s27, 9
    s_mul_i32 s76, s24, 8704
    v_mul_u32_u24 v15, 272, v8
    v_lshl_add_u32 v15, v9, 4, v15
    v_add_u32 v15, s76, v15
    s_lshl_b32 s68, s28, 4
    v_xor_b32 v47, s68, v8
    v_mul_u32_u24 v47, 272, v47
    v_lshl_add_u32 v47, v9, 4, v47
    v_add_u32 v47, s76, v47
    v_bfe_u32 v11, v8, 1, 3
    v_xor_b32 v11, v11, v9
    v_lshlrev_b32 v11, 4, v11
    v_lshl_add_u32 v11, v8, 7, v11
    s_lshl_b32 s68, s29, 13
    s_add_u32 s68, s68, 114688
    v_add_u32 v24, s68, v11
    v_xor_b32 v25, 32, v24
    v_xor_b32 v26, 64, v24
    v_xor_b32 v27, 96, v24
    v_and_b32 v11, 1, v3
    v_bfe_u32 v12, v5, 1, 1
    v_and_b32 v13, 1, v5
    v_lshl_add_u32 v13, v13, 1, v11
    v_lshlrev_b32 v13, 3, v13
    v_lshl_add_u32 v13, v12, 14, v13
    v_lshl_add_u32 v12, v4, 1, v12
    s_lshl_b32 s68, s28, 2
    v_xor_b32 v12, s68, v12
    v_lshl_add_u32 v13, v12, 5, v13
    v_lshl_add_u32 v14, v9, 3, v4
    v_lshl_add_u32 v32, v14, 8, v13
    v_xor_b32 v33, 32, v32
    v_xor_b32 v34, 64, v32
    v_xor_b32 v35, 96, v32
    v_add_u32 v28, 49152, v32
    v_add_u32 v29, 49152, v33
    v_add_u32 v30, 49152, v34
    v_add_u32 v31, 49152, v35
    v_lshl_add_u32 v12, v11, 2, v5
    s_mul_i32 s77, s29, 4160
    s_add_u32 s77, s77, 40832
    v_sub_u32 v12, v12, v14
    s_lshl_b32 s68, s28, 7
    s_add_u32 s69, s68, s77
    s_add_u32 s69, s69, 96
    v_lshl_add_u32 v36, v12, 3, s69
    s_lshl_b32 s36, s24, 12
    s_add_u32 s36, s36, 147456
    s_xor_b32 s37, s36, 4096
    s_cmp_lg_u32 s75, 0
    s_cbranch_scc1 L_helper1
    s_waitcnt vmcnt(3)
    v_mul_f32 v48, 0x3fb8aa3b, v48
    v_mul_f32 v52, 0x3fb8aa3b, v52
    v_exp_f32 v52, v52
    v_exp_f32 v48, v48
    s_nop 0
    v_cvt_pk_bf16_f32 v53, v52, v48
    v_lshlrev_b32 v52, 16, v53
    v_and_b32 v48, 0xffff0000, v53
    v_mul_f32 v48, v48, v52
    v_mul_f32 v49, v49, v52
    v_mul_f32 v48, 0xbfb8aa3b, v48
    v_mul_f32 v49, 0x3e22f983, v49
    v_add_f32 v52, v52, v52
    v_mul_f32 v56, 0x41000000, v48
    v_mul_f32 v57, 0x41000000, v49
    v_exp_f32 v56, v56
    v_fract_f32 v57, v57
    v_mul_f32 v60, 0x43800000, v48
    v_cos_f32 v58, v57
    v_sin_f32 v59, v57
    v_mul_f32 v61, 0x43800000, v49
    v_mul_f32 v68, v56, v58
    v_mul_f32 v69, v56, v59
    v_exp_f32 v60, v60
    v_fract_f32 v61, v61
    v_exp_f32 v48, v48
    v_fract_f32 v49, v49
    v_cos_f32 v62, v61
    v_sin_f32 v63, v61
    v_cos_f32 v54, v49
    v_sin_f32 v55, v49
    v_mul_f32 v64, v50, v52
    v_mul_f32 v65, v51, v52
    v_mul_f32 v70, v60, v62
    v_mul_f32 v71, v60, v63
    v_mul_f32 v66, v48, v54
    v_mul_f32 v67, v48, v55
    .p2align 3
    v_mov_b32 v48, 0x3f80
    v_cvt_pk_bf16_f32 v49, v68, v69
    v_pk_mul_f32 v[128:129], v[68:69], v[68:69] op_sel:[0,0] op_sel_hi:[1,0]
    v_pk_fma_f32 v[128:129], v[68:69], v[68:69], v[128:129] op_sel:[1,1,0] op_sel_hi:[0,1,1] neg_lo:[1,0,0]
    v_cvt_pk_bf16_f32 v50, v128, v129
    v_pk_mul_f32 v[130:131], v[128:129], v[68:69] op_sel:[0,0] op_sel_hi:[1,0]
    v_pk_fma_f32 v[130:131], v[128:129], v[68:69], v[130:131] op_sel:[1,1,0] op_sel_hi:[0,1,1] neg_lo:[1,0,0]
    v_cvt_pk_bf16_f32 v51, v130, v131
    v_pk_mul_f32 v[128:129], v[130:131], v[68:69] op_sel:[0,0] op_sel_hi:[1,0]
    v_pk_fma_f32 v[128:129], v[130:131], v[68:69], v[128:129] op_sel:[1,1,0] op_sel_hi:[0,1,1] neg_lo:[1,0,0]
    v_cvt_pk_bf16_f32 v52, v128, v129
    v_pk_mul_f32 v[130:131], v[128:129], v[68:69] op_sel:[0,0] op_sel_hi:[1,0]
    v_pk_fma_f32 v[130:131], v[128:129], v[68:69], v[130:131] op_sel:[1,1,0] op_sel_hi:[0,1,1] neg_lo:[1,0,0]
    v_cvt_pk_bf16_f32 v53, v130, v131
    v_pk_mul_f32 v[128:129], v[130:131], v[68:69] op_sel:[0,0] op_sel_hi:[1,0]
    v_pk_fma_f32 v[128:129], v[130:131], v[68:69], v[128:129] op_sel:[1,1,0] op_sel_hi:[0,1,1] neg_lo:[1,0,0]
    v_cvt_pk_bf16_f32 v54, v128, v129
    v_pk_mul_f32 v[130:131], v[128:129], v[68:69] op_sel:[0,0] op_sel_hi:[1,0]
    v_pk_fma_f32 v[130:131], v[128:129], v[68:69], v[130:131] op_sel:[1,1,0] op_sel_hi:[0,1,1] neg_lo:[1,0,0]
    v_cvt_pk_bf16_f32 v55, v130, v131
    s_mov_b32 m0, s76
    s_nop 0
    ds_write_addtid_b32 v48 offset:0
    ds_write_addtid_b32 v49 offset:272
    ds_write_addtid_b32 v50 offset:544
    ds_write_addtid_b32 v51 offset:816
    ds_write_addtid_b32 v52 offset:1088
    ds_write_addtid_b32 v53 offset:1360
    ds_write_addtid_b32 v54 offset:1632
    ds_write_addtid_b32 v55 offset:1904
    v_pk_mul_f32 v[128:129], v[130:131], v[68:69] op_sel:[0,0] op_sel_hi:[1,0]
    v_pk_fma_f32 v[128:129], v[130:131], v[68:69], v[128:129] op_sel:[1,1,0] op_sel_hi:[0,1,1] neg_lo:[1,0,0]
    v_cvt_pk_bf16_f32 v56, v128, v129
    v_pk_mul_f32 v[130:131], v[128:129], v[68:69] op_sel:[0,0] op_sel_hi:[1,0]
    v_pk_fma_f32 v[130:131], v[128:129], v[68:69], v[130:131] op_sel:[1,1,0] op_sel_hi:[0,1,1] neg_lo:[1,0,0]
    v_cvt_pk_bf16_f32 v57, v130, v131
    v_pk_mul_f32 v[128:129], v[130:131], v[68:69] op_sel:[0,0] op_sel_hi:[1,0]
    v_pk_fma_f32 v[128:129], v[130:131], v[68:69], v[128:129] op_sel:[1,1,0] op_sel_hi:[0,1,1] neg_lo:[1,0,0]
    v_cvt_pk_bf16_f32 v58, v128, v129
    v_pk_mul_f32 v[130:131], v[128:129], v[68:69] op_sel:[0,0] op_sel_hi:[1,0]
    v_pk_fma_f32 v[130:131], v[128:129], v[68:69], v[130:131] op_sel:[1,1,0] op_sel_hi:[0,1,1] neg_lo:[1,0,0]
    v_cvt_pk_bf16_f32 v59, v130, v131
    v_pk_mul_f32 v[128:129], v[130:131], v[68:69] op_sel:[0,0] op_sel_hi:[1,0]
    v_pk_fma_f32 v[128:129], v[130:131], v[68:69], v[128:129] op_sel:[1,1,0] op_sel_hi:[0,1,1] neg_lo:[1,0,0]
    v_cvt_pk_bf16_f32 v60, v128, v129
    v_pk_mul_f32 v[130:131], v[128:129], v[68:69] op_sel:[0,0] op_sel_hi:[1,0]
    v_pk_fma_f32 v[130:131], v[128:129], v[68:69], v[130:131] op_sel:[1,1,0] op_sel_hi:[0,1,1] neg_lo:[1,0,0]
    v_cvt_pk_bf16_f32 v61, v130, v131
    v_pk_mul_f32 v[128:129], v[130:131], v[68:69] op_sel:[0,0] op_sel_hi:[1,0]
    v_pk_fma_f32 v[128:129], v[130:131], v[68:69], v[128:129] op_sel:[1,1,0] op_sel_hi:[0,1,1] neg_lo:[1,0,0]
    v_cvt_pk_bf16_f32 v62, v128, v129
    v_pk_mul_f32 v[130:131], v[128:129], v[68:69] op_sel:[0,0] op_sel_hi:[1,0]
    v_pk_fma_f32 v[130:131], v[128:129], v[68:69], v[130:131] op_sel:[1,1,0] op_sel_hi:[0,1,1] neg_lo:[1,0,0]
    v_cvt_pk_bf16_f32 v63, v130, v131
    s_mov_b32 m0, s76
    s_nop 0
    ds_write_addtid_b32 v56 offset:2176
    ds_write_addtid_b32 v57 offset:2448
    ds_write_addtid_b32 v58 offset:2720
    ds_write_addtid_b32 v59 offset:2992
    ds_write_addtid_b32 v60 offset:3264
    ds_write_addtid_b32 v61 offset:3536
    ds_write_addtid_b32 v62 offset:3808
    ds_write_addtid_b32 v63 offset:4080
    v_pk_mul_f32 v[128:129], v[130:131], v[68:69] op_sel:[0,0] op_sel_hi:[1,0]
    v_pk_fma_f32 v[128:129], v[130:131], v[68:69], v[128:129] op_sel:[1,1,0] op_sel_hi:[0,1,1] neg_lo:[1,0,0]
    v_cvt_pk_bf16_f32 v48, v128, v129
    v_pk_mul_f32 v[130:131], v[128:129], v[68:69] op_sel:[0,0] op_sel_hi:[1,0]
    v_pk_fma_f32 v[130:131], v[128:129], v[68:69], v[130:131] op_sel:[1,1,0] op_sel_hi:[0,1,1] neg_lo:[1,0,0]
    v_cvt_pk_bf16_f32 v49, v130, v131
    v_pk_mul_f32 v[128:129], v[130:131], v[68:69] op_sel:[0,0] op_sel_hi:[1,0]
    v_pk_fma_f32 v[128:129], v[130:131], v[68:69], v[128:129] op_sel:[1,1,0] op_sel_hi:[0,1,1] neg_lo:[1,0,0]
    v_cvt_pk_bf16_f32 v50, v128, v129
    v_pk_mul_f32 v[130:131], v[128:129], v[68:69] op_sel:[0,0] op_sel_hi:[1,0]
    v_pk_fma_f32 v[130:131], v[128:129], v[68:69], v[130:131] op_sel:[1,1,0] op_sel_hi:[0,1,1] neg_lo:[1,0,0]
    v_cvt_pk_bf16_f32 v51, v130, v131
    v_pk_mul_f32 v[128:129], v[130:131], v[68:69] op_sel:[0,0] op_sel_hi:[1,0]
    v_pk_fma_f32 v[128:129], v[130:131], v[68:69], v[128:129] op_sel:[1,1,0] op_sel_hi:[0,1,1] neg_lo:[1,0,0]
    v_cvt_pk_bf16_f32 v52, v128, v129
    v_pk_mul_f32 v[130:131], v[128:129], v[68:69] op_sel:[0,0] op_sel_hi:[1,0]
    v_pk_fma_f32 v[130:131], v[128:129], v[68:69], v[130:131] op_sel:[1,1,0] op_sel_hi:[0,1,1] neg_lo:[1,0,0]
    v_cvt_pk_bf16_f32 v53, v130, v131
    v_pk_mul_f32 v[128:129], v[130:131], v[68:69] op_sel:[0,0] op_sel_hi:[1,0]
    v_pk_fma_f32 v[128:129], v[130:131], v[68:69], v[128:129] op_sel:[1,1,0] op_sel_hi:[0,1,1] neg_lo:[1,0,0]
    v_cvt_pk_bf16_f32 v54, v128, v129
    v_pk_mul_f32 v[130:131], v[128:129], v[68:69] op_sel:[0,0] op_sel_hi:[1,0]
    v_pk_fma_f32 v[130:131], v[128:129], v[68:69], v[130:131] op_sel:[1,1,0] op_sel_hi:[0,1,1] neg_lo:[1,0,0]
    v_cvt_pk_bf16_f32 v55, v130, v131
    s_mov_b32 m0, s76
    s_nop 0
    ds_write_addtid_b32 v48 offset:4352
    ds_write_addtid_b32 v49 offset:4624
    ds_write_addtid_b32 v50 offset:4896
    ds_write_addtid_b32 v51 offset:5168
    ds_write_addtid_b32 v52 offset:5440
    ds_write_addtid_b32 v53 offset:5712
    ds_write_addtid_b32 v54 offset:5984
    ds_write_addtid_b32 v55 offset:6256
    v_pk_mul_f32 v[128:129], v[130:131], v[68:69] op_sel:[0,0] op_sel_hi:[1,0]
    v_pk_fma_f32 v[128:129], v[130:131], v[68:69], v[128:129] op_sel:[1,1,0] op_sel_hi:[0,1,1] neg_lo:[1,0,0]
    v_cvt_pk_bf16_f32 v56, v128, v129
    v_pk_mul_f32 v[130:131], v[128:129], v[68:69] op_sel:[0,0] op_sel_hi:[1,0]
    v_pk_fma_f32 v[130:131], v[128:129], v[68:69], v[130:131] op_sel:[1,1,0] op_sel_hi:[0,1,1] neg_lo:[1,0,0]
    v_cvt_pk_bf16_f32 v57, v130, v131
    v_pk_mul_f32 v[128:129], v[130:131], v[68:69] op_sel:[0,0] op_sel_hi:[1,0]
    v_pk_fma_f32 v[128:129], v[130:131], v[68:69], v[128:129] op_sel:[1,1,0] op_sel_hi:[0,1,1] neg_lo:[1,0,0]
    v_cvt_pk_bf16_f32 v58, v128, v129
    v_pk_mul_f32 v[130:131], v[128:129], v[68:69] op_sel:[0,0] op_sel_hi:[1,0]
    v_pk_fma_f32 v[130:131], v[128:129], v[68:69], v[130:131] op_sel:[1,1,0] op_sel_hi:[0,1,1] neg_lo:[1,0,0]
    v_cvt_pk_bf16_f32 v59, v130, v131
    v_pk_mul_f32 v[128:129], v[130:131], v[68:69] op_sel:[0,0] op_sel_hi:[1,0]
    v_pk_fma_f32 v[128:129], v[130:131], v[68:69], v[128:129] op_sel:[1,1,0] op_sel_hi:[0,1,1] neg_lo:[1,0,0]
    v_cvt_pk_bf16_f32 v60, v128, v129
    v_pk_mul_f32 v[130:131], v[128:129], v[68:69] op_sel:[0,0] op_sel_hi:[1,0]
    v_pk_fma_f32 v[130:131], v[128:129], v[68:69], v[130:131] op_sel:[1,1,0] op_sel_hi:[0,1,1] neg_lo:[1,0,0]
    v_cvt_pk_bf16_f32 v61, v130, v131
    v_pk_mul_f32 v[128:129], v[130:131], v[68:69] op_sel:[0,0] op_sel_hi:[1,0]
    v_pk_fma_f32 v[128:129], v[130:131], v[68:69], v[128:129] op_sel:[1,1,0] op_sel_hi:[0,1,1] neg_lo:[1,0,0]
    v_cvt_pk_bf16_f32 v62, v128, v129
    v_pk_mul_f32 v[130:131], v[128:129], v[68:69] op_sel:[0,0] op_sel_hi:[1,0]
    v_pk_fma_f32 v[130:131], v[128:129], v[68:69], v[130:131] op_sel:[1,1,0] op_sel_hi:[0,1,1] neg_lo:[1,0,0]
    v_cvt_pk_bf16_f32 v63, v130, v131
    s_mov_b32 m0, s76
    s_nop 0
    ds_write_addtid_b32 v56 offset:6528
    ds_write_addtid_b32 v57 offset:6800
    ds_write_addtid_b32 v58 offset:7072
    ds_write_addtid_b32 v59 offset:7344
    ds_write_addtid_b32 v60 offset:7616
    ds_write_addtid_b32 v61 offset:7888
    ds_write_addtid_b32 v62 offset:8160
    ds_write_addtid_b32 v63 offset:8432
    ds_read_b128 a[112:115], v15 offset:0
    ds_read_b128 a[116:119], v15 offset:32
    ds_read_b128 a[120:123], v15 offset:64
    ds_read_b128 a[124:127], v15 offset:96
    ds_read_b128 a[128:131], v15 offset:128
    ds_read_b128 a[132:135], v15 offset:160
    ds_read_b128 a[136:139], v15 offset:192
    ds_read_b128 a[140:143], v15 offset:224
    v_cvt_pk_bf16_f32 v48, v64, -v65
    v_pk_mul_f32 v[132:133], v[64:65], v[66:67] op_sel:[0,0] op_sel_hi:[1,0]
    v_pk_fma_f32 v[132:133], v[64:65], v[66:67], v[132:133] op_sel:[1,1,0] op_sel_hi:[0,1,1] neg_lo:[1,0,0]
    v_cvt_pk_bf16_f32 v49, v132, -v133
    v_pk_mul_f32 v[134:135], v[132:133], v[66:67] op_sel:[0,0] op_sel_hi:[1,0]
    v_pk_fma_f32 v[134:135], v[132:133], v[66:67], v[134:135] op_sel:[1,1,0] op_sel_hi:[0,1,1] neg_lo:[1,0,0]
    v_cvt_pk_bf16_f32 v50, v134, -v135
    v_pk_mul_f32 v[136:137], v[134:135], v[66:67] op_sel:[0,0] op_sel_hi:[1,0]
    v_pk_fma_f32 v[136:137], v[134:135], v[66:67], v[136:137] op_sel:[1,1,0] op_sel_hi:[0,1,1] neg_lo:[1,0,0]
    v_cvt_pk_bf16_f32 v51, v136, -v137
    v_pk_mul_f32 v[138:139], v[136:137], v[66:67] op_sel:[0,0] op_sel_hi:[1,0]
    v_pk_fma_f32 v[138:139], v[136:137], v[66:67], v[138:139] op_sel:[1,1,0] op_sel_hi:[0,1,1] neg_lo:[1,0,0]
    v_cvt_pk_bf16_f32 v52, v138, -v139
    v_pk_mul_f32 v[140:141], v[138:139], v[66:67] op_sel:[0,0] op_sel_hi:[1,0]
    v_pk_fma_f32 v[140:141], v[138:139], v[66:67], v[140:141] op_sel:[1,1,0] op_sel_hi:[0,1,1] neg_lo:[1,0,0]
    v_cvt_pk_bf16_f32 v53, v140, -v141
    v_pk_mul_f32 v[142:143], v[140:141], v[66:67] op_sel:[0,0] op_sel_hi:[1,0]
    v_pk_fma_f32 v[142:143], v[140:141], v[66:67], v[142:143] op_sel:[1,1,0] op_sel_hi:[0,1,1] neg_lo:[1,0,0]
    v_cvt_pk_bf16_f32 v54, v142, -v143
    s_mov_b32 m0, s76
    s_nop 0
    ds_write_addtid_b32 v48 offset:0
    ds_write_addtid_b32 v49 offset:272
    ds_write_addtid_b32 v50 offset:544
    ds_write_addtid_b32 v51 offset:816
    ds_write_addtid_b32 v52 offset:1088
    ds_write_addtid_b32 v53 offset:1360
    ds_write_addtid_b32 v54 offset:1632
    v_pk_mul_f32 v[144:145], v[142:143], v[66:67] op_sel:[0,0] op_sel_hi:[1,0]
    v_pk_fma_f32 v[144:145], v[142:143], v[66:67], v[144:145] op_sel:[1,1,0] op_sel_hi:[0,1,1] neg_lo:[1,0,0]
    v_cvt_pk_bf16_f32 v56, v144, -v145
    v_pk_mul_f32 v[146:147], v[144:145], v[66:67] op_sel:[0,0] op_sel_hi:[1,0]
    v_pk_fma_f32 v[146:147], v[144:145], v[66:67], v[146:147] op_sel:[1,1,0] op_sel_hi:[0,1,1] neg_lo:[1,0,0]
    v_pk_mul_f32 v[148:149], v[64:65], v[70:71] op_sel:[0,0] op_sel_hi:[1,0]
    v_pk_fma_f32 v[148:149], v[64:65], v[70:71], v[148:149] op_sel:[1,1,0] op_sel_hi:[0,1,1] neg_lo:[1,0,0]
    v_cvt_pk_bf16_f32 v57, v148, -v149
    v_pk_mul_f32 v[150:151], v[134:135], v[70:71] op_sel:[0,0] op_sel_hi:[1,0]
    v_pk_fma_f32 v[150:151], v[134:135], v[70:71], v[150:151] op_sel:[1,1,0] op_sel_hi:[0,1,1] neg_lo:[1,0,0]
    v_cvt_pk_bf16_f32 v58, v150, -v151
    v_pk_mul_f32 v[152:153], v[138:139], v[70:71] op_sel:[0,0] op_sel_hi:[1,0]
    v_pk_fma_f32 v[152:153], v[138:139], v[70:71], v[152:153] op_sel:[1,1,0] op_sel_hi:[0,1,1] neg_lo:[1,0,0]
    v_cvt_pk_bf16_f32 v59, v152, -v153
    v_pk_mul_f32 v[154:155], v[142:143], v[70:71] op_sel:[0,0] op_sel_hi:[1,0]
    v_pk_fma_f32 v[154:155], v[142:143], v[70:71], v[154:155] op_sel:[1,1,0] op_sel_hi:[0,1,1] neg_lo:[1,0,0]
    v_cvt_pk_bf16_f32 v60, v154, -v155
    v_pk_mul_f32 v[156:157], v[146:147], v[70:71] op_sel:[0,0] op_sel_hi:[1,0]
    v_pk_fma_f32 v[156:157], v[146:147], v[70:71], v[156:157] op_sel:[1,1,0] op_sel_hi:[0,1,1] neg_lo:[1,0,0]
    v_cvt_pk_bf16_f32 v61, v156, -v157
    v_pk_mul_f32 v[158:159], v[148:149], v[70:71] op_sel:[0,0] op_sel_hi:[1,0]
    v_pk_fma_f32 v[158:159], v[148:149], v[70:71], v[158:159] op_sel:[1,1,0] op_sel_hi:[0,1,1] neg_lo:[1,0,0]
    v_cvt_pk_bf16_f32 v62, v158, -v159
    s_mov_b32 m0, s76
    s_nop 0
    ds_write_addtid_b32 v56 offset:1904
    ds_write_addtid_b32 v57 offset:2176
    ds_write_addtid_b32 v58 offset:2448
    ds_write_addtid_b32 v59 offset:2720
    ds_write_addtid_b32 v59 offset:3264
    ds_write_addtid_b32 v60 offset:3536
    ds_write_addtid_b32 v61 offset:3808
    ds_write_addtid_b32 v62 offset:4352
    v_pk_mul_f32 v[160:161], v[152:153], v[70:71] op_sel:[0,0] op_sel_hi:[1,0]
    v_pk_fma_f32 v[160:161], v[152:153], v[70:71], v[160:161] op_sel:[1,1,0] op_sel_hi:[0,1,1] neg_lo:[1,0,0]
    v_cvt_pk_bf16_f32 v48, v160, -v161
    v_pk_mul_f32 v[162:163], v[156:157], v[70:71] op_sel:[0,0] op_sel_hi:[1,0]
    v_pk_fma_f32 v[162:163], v[156:157], v[70:71], v[162:163] op_sel:[1,1,0] op_sel_hi:[0,1,1] neg_lo:[1,0,0]
    v_cvt_pk_bf16_f32 v49, v162, -v163
    v_pk_mul_f32 v[164:165], v[158:159], v[70:71] op_sel:[0,0] op_sel_hi:[1,0]
    v_pk_fma_f32 v[164:165], v[158:159], v[70:71], v[164:165] op_sel:[1,1,0] op_sel_hi:[0,1,1] neg_lo:[1,0,0]
    v_cvt_pk_bf16_f32 v50, v164, -v165
    v_pk_mul_f32 v[166:167], v[160:161], v[70:71] op_sel:[0,0] op_sel_hi:[1,0]
    v_pk_fma_f32 v[166:167], v[160:161], v[70:71], v[166:167] op_sel:[1,1,0] op_sel_hi:[0,1,1] neg_lo:[1,0,0]
    v_cvt_pk_bf16_f32 v51, v166, -v167
    v_pk_mul_f32 v[168:169], v[162:163], v[70:71] op_sel:[0,0] op_sel_hi:[1,0]
    v_pk_fma_f32 v[168:169], v[162:163], v[70:71], v[168:169] op_sel:[1,1,0] op_sel_hi:[0,1,1] neg_lo:[1,0,0]
    v_cvt_pk_bf16_f32 v52, v168, -v169
    v_pk_mul_f32 v[170:171], v[164:165], v[70:71] op_sel:[0,0] op_sel_hi:[1,0]
    v_pk_fma_f32 v[170:171], v[164:165], v[70:71], v[170:171] op_sel:[1,1,0] op_sel_hi:[0,1,1] neg_lo:[1,0,0]
    v_cvt_pk_bf16_f32 v53, v170, -v171
    v_pk_mul_f32 v[172:173], v[168:169], v[70:71] op_sel:[0,0] op_sel_hi:[1,0]
    v_pk_fma_f32 v[172:173], v[168:169], v[70:71], v[172:173] op_sel:[1,1,0] op_sel_hi:[0,1,1] neg_lo:[1,0,0]
    v_cvt_pk_bf16_f32 v54, v172, -v173
    s_mov_b32 m0, s76
    s_nop 0
    ds_write_addtid_b32 v48 offset:4624
    ds_write_addtid_b32 v49 offset:4896
    ds_write_addtid_b32 v50 offset:5440
    ds_write_addtid_b32 v51 offset:5712
    ds_write_addtid_b32 v52 offset:5984
    ds_write_addtid_b32 v53 offset:6528
    ds_write_addtid_b32 v54 offset:6800
    v_pk_mul_f32 v[174:175], v[170:171], v[70:71] op_sel:[0,0] op_sel_hi:[1,0]
    v_pk_fma_f32 v[174:175], v[170:171], v[70:71], v[174:175] op_sel:[1,1,0] op_sel_hi:[0,1,1] neg_lo:[1,0,0]
    v_cvt_pk_bf16_f32 v56, v174, -v175
    v_pk_mul_f32 v[176:177], v[172:173], v[70:71] op_sel:[0,0] op_sel_hi:[1,0]
    v_pk_fma_f32 v[176:177], v[172:173], v[70:71], v[176:177] op_sel:[1,1,0] op_sel_hi:[0,1,1] neg_lo:[1,0,0]
    v_cvt_pk_bf16_f32 v57, v176, -v177
    v_pk_mul_f32 v[178:179], v[174:175], v[70:71] op_sel:[0,0] op_sel_hi:[1,0]
    v_pk_fma_f32 v[178:179], v[174:175], v[70:71], v[178:179] op_sel:[1,1,0] op_sel_hi:[0,1,1] neg_lo:[1,0,0]
    v_cvt_pk_bf16_f32 v58, v178, -v179
    v_pk_mul_f32 v[180:181], v[176:177], v[70:71] op_sel:[0,0] op_sel_hi:[1,0]
    v_pk_fma_f32 v[180:181], v[176:177], v[70:71], v[180:181] op_sel:[1,1,0] op_sel_hi:[0,1,1] neg_lo:[1,0,0]
    v_cvt_pk_bf16_f32 v59, v180, -v181
    v_pk_mul_f32 v[182:183], v[178:179], v[70:71] op_sel:[0,0] op_sel_hi:[1,0]
    v_pk_fma_f32 v[182:183], v[178:179], v[70:71], v[182:183] op_sel:[1,1,0] op_sel_hi:[0,1,1] neg_lo:[1,0,0]
    v_cvt_pk_bf16_f32 v60, v182, -v183
    v_pk_mul_f32 v[184:185], v[180:181], v[70:71] op_sel:[0,0] op_sel_hi:[1,0]
    v_pk_fma_f32 v[184:185], v[180:181], v[70:71], v[184:185] op_sel:[1,1,0] op_sel_hi:[0,1,1] neg_lo:[1,0,0]
    v_cvt_pk_bf16_f32 v61, v184, -v185
    s_mov_b32 m0, s76
    s_nop 0
    ds_write_addtid_b32 v56 offset:7072
    ds_write_addtid_b32 v57 offset:7344
    ds_write_addtid_b32 v58 offset:7616
    ds_write_addtid_b32 v59 offset:7888
    ds_write_addtid_b32 v60 offset:8160
    ds_write_addtid_b32 v61 offset:8432
    ds_read_b128 a[144:147], v47 offset:0
    ds_read_b128 a[148:151], v47 offset:32
    ds_read_b128 a[152:155], v47 offset:64
    ds_read_b128 a[156:159], v47 offset:96
    ds_read_b128 a[160:163], v47 offset:128
    ds_read_b128 a[164:167], v47 offset:160
    ds_read_b128 a[168:171], v47 offset:192
    ds_read_b128 a[172:175], v47 offset:224
    s_waitcnt lgkmcnt(7)
    v_mfma_f32_32x32x16_bf16 v[112:127], a[144:147], a[112:115], 0
    s_add_u32 m0, s70, 0
    s_xor_b32 s73, s27, 0
    buffer_load_dwordx4 v20, s[4:7], s73 offen offset:0 lds
    v_add_u32 v14, s36, v38
    v_add_u32 v10, s37, v38
    s_waitcnt lgkmcnt(6)
    v_mfma_f32_32x32x16_bf16 v[112:127], a[148:151], a[116:119], v[112:127]
    buffer_load_dwordx4 v21, s[4:7], s73 offen offset:1024 lds
    v_lshl_add_u32 v12, v8, 4, s77
    v_lshl_add_u32 v13, v9, 3, v12
    s_waitcnt lgkmcnt(5)
    v_mfma_f32_32x32x16_bf16 v[112:127], a[152:155], a[120:123], v[112:127]
    buffer_load_dwordx4 v22, s[4:7], s73 offen offset:2048 lds
    v_lshl_add_u32 v11, v9, 9, v12
    v_lshl_add_u32 v15, v9, 10, v12
    s_waitcnt lgkmcnt(4)
    v_mfma_f32_32x32x16_bf16 v[112:127], a[156:159], a[124:127], v[112:127]
    buffer_load_dwordx4 v23, s[4:7], s73 offen offset:3072 lds
    v_cmp_eq_u32 vcc, 0, v1
    s_nop 0
    s_waitcnt lgkmcnt(3)
    v_mfma_f32_32x32x16_bf16 v[112:127], a[160:163], a[128:131], v[112:127]
    s_add_u32 m0, s71, 49152
    s_add_u32 s74, s72, 0
    buffer_load_dwordx4 v16, s[8:11], s74 offen offset:0 lds
    v_and_b32 v12, 1, v1
    v_cndmask_b32 v46, 0, v46, vcc
    s_waitcnt lgkmcnt(2)
    v_mfma_f32_32x32x16_bf16 v[112:127], a[164:167], a[132:135], v[112:127]
    buffer_load_dwordx4 v17, s[8:11], s74 offen offset:1024 lds
    v_cmp_eq_u32 vcc, 1, v12
    v_and_b32 v47, 15, v1
    s_waitcnt lgkmcnt(1)
    v_mfma_f32_32x32x16_bf16 v[112:127], a[168:171], a[136:139], v[112:127]
    buffer_load_dwordx4 v18, s[8:11], s74 offen offset:2048 lds
    v_lshl_add_u32 v47, v47, 2, s77
    s_waitcnt lgkmcnt(0)
    v_mfma_f32_32x32x16_bf16 v[112:127], a[172:175], a[140:143], v[112:127]
    buffer_load_dwordx4 v19, s[8:11], s74 offen offset:3072 lds
    s_add_u32 m0, s71, 53248
    s_add_u32 s74, s72, 57344
    buffer_load_dwordx4 v16, s[8:11], s74 offen offset:0 lds
    buffer_load_dwordx4 v17, s[8:11], s74 offen offset:1024 lds
    buffer_load_dwordx4 v18, s[8:11], s74 offen offset:2048 lds
    buffer_load_dwordx4 v19, s[8:11], s74 offen offset:3072 lds
    s_nop 4
    ds_write_b128 v14, v[120:123] offset:0
    ds_write_b128 v14, v[124:127] offset:1024
    s_waitcnt lgkmcnt(0)
    s_barrier
    ds_read_b128 v[48:51], v10 offset:0
    ds_read_b128 v[52:55], v10 offset:1024
    s_add_u32 m0, s70, 16384
    s_xor_b32 s73, s27, 128
    buffer_load_dwordx4 v20, s[4:7], s73 offen offset:0 lds
    buffer_load_dwordx4 v21, s[4:7], s73 offen offset:1024 lds
    s_waitcnt lgkmcnt(1)
    v_pk_add_f32 v[112:113], v[112:113], v[48:49]
    v_pk_add_f32 v[114:115], v[114:115], v[50:51]
    s_waitcnt lgkmcnt(0)
    v_pk_add_f32 v[116:117], v[116:117], v[52:53]
    v_pk_add_f32 v[118:119], v[118:119], v[54:55]
    s_cmp_lg_u32 s28, 0
    s_cbranch_scc1 L_koddm
    v_add_f32 v112, v112, v46
    v_cvt_pk_bf16_f32 v49, v114, v115
    v_cvt_pk_bf16_f32 v48, v112, v113
    v_cvt_pk_bf16_f32 v50, v116, v116
    v_cvt_pk_bf16_f32 v51, v117, v118
    ds_write_b64 v13, v[48:49] offset:64
    ds_write_b64 v13, v[50:51] offset:576
    ds_write_b32 v47, v40
    s_branch L_kdonem
L_koddm:
    v_cvt_pk_bf16_f32 v52, v112, v112
    v_cvt_pk_bf16_f32 v53, v112, v113
    v_cvt_pk_bf16_f32 v54, v113, v113
    v_cvt_pk_bf16_f32 v55, v114, v114
    v_cndmask_b32 v12, v116, v117, vcc
    v_cvt_pk_bf16_f32 v56, v116, v116
    v_cvt_pk_bf16_f32 v57, v116, v116
    v_cvt_pk_bf16_f32 v58, v12, v117
    v_cvt_pk_bf16_f32 v59, v117, v117
    v_cndmask_b32 v12, v118, v119, vcc
    v_cvt_pk_bf16_f32 v60, v118, v118
    v_cvt_pk_bf16_f32 v61, v118, v118
    v_cvt_pk_bf16_f32 v62, v12, v119
    v_cvt_pk_bf16_f32 v63, v119, v119
    ds_write_b128 v11, v[52:55] offset:1088
    ds_write_b128 v15, v[56:59] offset:2112
    ds_write_b128 v15, v[60:63] offset:2624
L_kdonem:
    buffer_load_dwordx4 v22, s[4:7], s73 offen offset:2048 lds
    buffer_load_dwordx4 v23, s[4:7], s73 offen offset:3072 lds
    s_add_u32 m0, s71, 81920
    s_add_u32 s74, s72, 229376
    buffer_load_dwordx4 v16, s[8:11], s74 offen offset:0 lds
    buffer_load_dwordx4 v17, s[8:11], s74 offen offset:1024 lds
    buffer_load_dwordx4 v18, s[8:11], s74 offen offset:2048 lds
    buffer_load_dwordx4 v19, s[8:11], s74 offen offset:3072 lds
    global_load_dword v41, v40, s[62:63] sc1
    s_waitcnt lgkmcnt(0)
    s_waitcnt vmcnt(9)
    s_barrier
    ds_read_b128 v[80:83], v24 offset:0
    ds_read_b64_tr_b16 v[64:65], v28 offset:0
    ds_read_b64_tr_b16 v[66:67], v28 offset:1024
    ds_read_b128 v[84:87], v24 offset:4096
    ds_read_b64_tr_b16 v[68:69], v29 offset:0
    ds_read_b64_tr_b16 v[70:71], v29 offset:1024
    ds_read_b64_tr_b16 v[72:73], v30 offset:0
    ds_read_b64_tr_b16 v[74:75], v30 offset:1024
    ds_read_b64_tr_b16 v[76:77], v31 offset:0
    ds_read_b64_tr_b16 v[78:79], v31 offset:1024
    s_waitcnt lgkmcnt(4)
    v_mfma_f32_32x32x16_bf16 v[128:143], v[64:67], v[80:83], 0
    ds_read_b128 v[104:107], v25 offset:0
    ds_read_b64_tr_b16 v[88:89], v28 offset:4096
    s_add_u32 m0, s71, 86016
    s_add_u32 s74, s72, 286720
    buffer_load_dwordx4 v16, s[8:11], s74 offen offset:0 lds
    v_mfma_f32_32x32x16_bf16 v[192:207], v[64:67], v[84:87], 0
    ds_read_b64_tr_b16 v[90:91], v28 offset:5120
    ds_read_b128 v[108:111], v25 offset:4096
    v_mfma_f32_32x32x16_bf16 v[144:159], v[68:71], v[80:83], 0
    buffer_load_dwordx4 v17, s[8:11], s74 offen offset:1024 lds
    ds_read_b64_tr_b16 a[112:113], v36 offset:32
    v_mfma_f32_32x32x16_bf16 v[208:223], v[68:71], v[84:87], 0
    ds_read_b64_tr_b16 v[92:93], v29 offset:4096
    ds_read_b64_tr_b16 v[94:95], v29 offset:5120
    ds_read_b64_tr_b16 a[114:115], v36 offset:0
    s_waitcnt lgkmcnt(8)
    v_mfma_f32_32x32x16_bf16 v[160:175], v[72:75], v[80:83], 0
    ds_read_b64_tr_b16 v[96:97], v30 offset:4096
    ds_read_b64_tr_b16 v[98:99], v30 offset:5120
    buffer_load_dwordx4 v18, s[8:11], s74 offen offset:2048 lds
    s_mov_b32 s20, s60
    v_mfma_f32_32x32x16_bf16 v[224:239], v[72:75], v[84:87], 0
    ds_read_b64_tr_b16 a[116:117], v36 offset:288
    s_mov_b32 s21, s61
    v_mfma_f32_32x32x16_bf16 v[176:191], v[76:79], v[80:83], 0
    ds_read_b64_tr_b16 v[100:101], v31 offset:4096
    ds_read_b64_tr_b16 v[102:103], v31 offset:5120
    buffer_load_dwordx4 v19, s[8:11], s74 offen offset:3072 lds
    v_mfma_f32_32x32x16_bf16 v[240:255], v[76:79], v[84:87], 0
    ds_read_b64_tr_b16 a[118:119], v36 offset:256
    ds_read_b64_tr_b16 a[120:121], v36 offset:544
    s_mov_b32 s22, 0x200000
    s_mov_b32 s23, 0x20000
    s_waitcnt lgkmcnt(8)
    v_mfma_f32_32x32x16_bf16 v[128:143], v[88:91], v[104:107], v[128:143]
    ds_read_b128 v[80:83], v26 offset:0
    ds_read_b64_tr_b16 v[64:65], v28 offset:8192
    s_add_u32 m0, s70, 32768
    s_xor_b32 s73, s27, 256
    buffer_load_dwordx4 v20, s[4:7], s73 offen offset:0 lds
    v_mfma_f32_32x32x16_bf16 v[192:207], v[88:91], v[108:111], v[192:207]
    ds_read_b64_tr_b16 v[66:67], v28 offset:9216
    ds_read_b128 v[84:87], v26 offset:4096
    v_mfma_f32_32x32x16_bf16 v[144:159], v[92:95], v[104:107], v[144:159]
    buffer_load_dwordx4 v21, s[4:7], s73 offen offset:1024 lds
    ds_read_b64_tr_b16 a[122:123], v36 offset:512
    s_lshl_b32 s41, s24, 10
    s_add_u32 s41, s41, 15859712
    v_mfma_f32_32x32x16_bf16 v[208:223], v[92:95], v[108:111], v[208:223]
    ds_read_b64_tr_b16 v[68:69], v29 offset:8192
    ds_read_b64_tr_b16 v[70:71], v29 offset:9216
    ds_read_b64_tr_b16 a[124:125], v36 offset:800
    s_waitcnt lgkmcnt(10)
    v_mfma_f32_32x32x16_bf16 v[160:175], v[96:99], v[104:107], v[160:175]
    ds_read_b64_tr_b16 v[72:73], v30 offset:8192
    ds_read_b64_tr_b16 v[74:75], v30 offset:9216
    buffer_load_dwordx4 v22, s[4:7], s73 offen offset:2048 lds
    v_mfma_f32_32x32x16_bf16 v[224:239], v[96:99], v[108:111], v[224:239]
    ds_read_b64_tr_b16 a[126:127], v36 offset:768
    s_lshl_b32 s79, s33, 6
    v_mfma_f32_32x32x16_bf16 v[176:191], v[100:103], v[104:107], v[176:191]
    ds_read_b64_tr_b16 v[76:77], v31 offset:8192
    ds_read_b64_tr_b16 v[78:79], v31 offset:9216
    buffer_load_dwordx4 v23, s[4:7], s73 offen offset:3072 lds
    v_mfma_f32_32x32x16_bf16 v[240:255], v[100:103], v[108:111], v[240:255]
    ds_read_b64_tr_b16 a[128:129], v36 offset:1056
    s_lshl_b32 s69, s29, 5
    s_add_u32 s79, s79, s69
    s_waitcnt lgkmcnt(7)
    v_mfma_f32_32x32x16_bf16 v[128:143], v[64:67], v[80:83], v[128:143]
    ds_read_b128 v[104:107], v27 offset:0
    ds_read_b64_tr_b16 v[88:89], v28 offset:12288
    s_add_u32 m0, s71, 0
    s_add_u32 s74, s72, 458752
    buffer_load_dwordx4 v16, s[8:11], s74 offen offset:0 lds
    v_mfma_f32_32x32x16_bf16 v[192:207], v[64:67], v[84:87], v[192:207]
    ds_read_b64_tr_b16 v[90:91], v28 offset:13312
    ds_read_b128 v[108:111], v27 offset:4096
    ds_read_b64_tr_b16 a[130:131], v36 offset:1024
    v_mfma_f32_32x32x16_bf16 v[144:159], v[68:71], v[80:83], v[144:159]
    buffer_load_dwordx4 v17, s[8:11], s74 offen offset:1024 lds
    s_mov_b32 s16, s56
    s_mov_b32 s17, s57
    v_mfma_f32_32x32x16_bf16 v[208:223], v[68:71], v[84:87], v[208:223]
    ds_read_b64_tr_b16 v[92:93], v29 offset:12288
    ds_read_b64_tr_b16 v[94:95], v29 offset:13312
    ds_read_b64_tr_b16 a[132:133], v36 offset:1312
    s_waitcnt lgkmcnt(9)
    v_mfma_f32_32x32x16_bf16 v[160:175], v[72:75], v[80:83], v[160:175]
    ds_read_b64_tr_b16 v[96:97], v30 offset:12288
    ds_read_b64_tr_b16 v[98:99], v30 offset:13312
    buffer_load_dwordx4 v18, s[8:11], s74 offen offset:2048 lds
    v_mfma_f32_32x32x16_bf16 v[224:239], v[72:75], v[84:87], v[224:239]
    ds_read_b64_tr_b16 a[134:135], v36 offset:1280
    ds_read_b64_tr_b16 a[136:137], v36 offset:1568
    s_mov_b32 s18, 1835008
    v_mfma_f32_32x32x16_bf16 v[176:191], v[76:79], v[80:83], v[176:191]
    ds_read_b64_tr_b16 v[100:101], v31 offset:12288
    ds_read_b64_tr_b16 v[102:103], v31 offset:13312
    buffer_load_dwordx4 v19, s[8:11], s74 offen offset:3072 lds
    v_mfma_f32_32x32x16_bf16 v[240:255], v[76:79], v[84:87], v[240:255]
    s_mul_i32 s69, s24, 28
    s_waitcnt lgkmcnt(7)
    v_mfma_f32_32x32x16_bf16 v[128:143], v[88:91], v[104:107], v[128:143]
    s_add_u32 m0, s71, 4096
    s_add_u32 s74, s72, 516096
    buffer_load_dwordx4 v16, s[8:11], s74 offen offset:0 lds
    ds_read_b64_tr_b16 a[138:139], v36 offset:1536
    s_xor_b32 s42, s34, s33
    v_mfma_f32_32x32x16_bf16 v[192:207], v[88:91], v[108:111], v[192:207]
    s_waitcnt lgkmcnt(0)
    s_waitcnt vmcnt(9)
    s_barrier
    ds_read_b128 v[80:83], v24 offset:16384
    ds_read_b64_tr_b16 v[64:65], v28 offset:32768
    v_mfma_f32_32x32x16_bf16 v[144:159], v[92:95], v[104:107], v[144:159]
    ds_read_b64_tr_b16 v[66:67], v28 offset:33792
    ds_read_b128 v[84:87], v24 offset:20480
    ds_read_b64_tr_b16 a[140:141], v36 offset:1824
    s_and_b32 s42, s42, 1
    v_mfma_f32_32x32x16_bf16 v[208:223], v[92:95], v[108:111], v[208:223]
    ds_read_b64_tr_b16 v[68:69], v29 offset:32768
    ds_read_b64_tr_b16 v[70:71], v29 offset:33792
    buffer_load_dwordx4 v17, s[8:11], s74 offen offset:1024 lds
    v_mfma_f32_32x32x16_bf16 v[160:175], v[96:99], v[104:107], v[160:175]
    ds_read_b64_tr_b16 v[72:73], v30 offset:32768
    ds_read_b64_tr_b16 v[74:75], v30 offset:33792
    ds_read_b64_tr_b16 a[142:143], v36 offset:1792
    s_mul_i32 s42, s42, 14
    v_mfma_f32_32x32x16_bf16 v[224:239], v[96:99], v[108:111], v[224:239]
    ds_read_b64_tr_b16 v[76:77], v31 offset:32768
    ds_read_b64_tr_b16 v[78:79], v31 offset:33792
    buffer_load_dwordx4 v18, s[8:11], s74 offen offset:2048 lds
    s_add_u32 s69, s69, s42
    v_mfma_f32_32x32x16_bf16 v[176:191], v[100:103], v[104:107], v[176:191]
    ds_read_b64_tr_b16 a[144:145], v36 offset:2080
    s_lshl_b32 s80, s69, 14
    v_mfma_f32_32x32x16_bf16 v[240:255], v[100:103], v[108:111], v[240:255]
    buffer_load_dwordx4 v19, s[8:11], s74 offen offset:3072 lds
    ds_read_b64_tr_b16 a[146:147], v36 offset:2048
    s_waitcnt lgkmcnt(7)
    v_mfma_f32_32x32x16_bf16 v[128:143], v[64:67], v[80:83], v[128:143]
    ds_read_b128 v[104:107], v25 offset:16384
    ds_read_b64_tr_b16 v[88:89], v28 offset:36864
    ds_read_b64_tr_b16 a[148:149], v36 offset:2336
    s_lshl_b32 s68, s34, 7
    v_mfma_f32_32x32x16_bf16 v[192:207], v[64:67], v[84:87], v[192:207]
    ds_read_b64_tr_b16 v[90:91], v28 offset:37888
    ds_read_b128 v[108:111], v25 offset:20480
    v_mfma_f32_32x32x16_bf16 v[144:159], v[68:71], v[80:83], v[144:159]
    s_add_u32 m0, s70, 0
    s_xor_b32 s73, s27, 384
    buffer_load_dwordx4 v20, s[4:7], s73 offen offset:0 lds
    ds_read_b64_tr_b16 a[150:151], v36 offset:2304
    s_add_u32 s80, s80, s68
    v_mfma_f32_32x32x16_bf16 v[208:223], v[68:71], v[84:87], v[208:223]
    ds_read_b64_tr_b16 v[92:93], v29 offset:36864
    ds_read_b64_tr_b16 v[94:95], v29 offset:37888
    ds_read_b64_tr_b16 a[152:153], v36 offset:2592
    s_waitcnt lgkmcnt(11)
    v_mfma_f32_32x32x16_bf16 v[160:175], v[72:75], v[80:83], v[160:175]
    ds_read_b64_tr_b16 v[96:97], v30 offset:36864
    ds_read_b64_tr_b16 v[98:99], v30 offset:37888
    buffer_load_dwordx4 v21, s[4:7], s73 offen offset:1024 lds
    s_lshl_b32 s46, s42, 15
    v_mfma_f32_32x32x16_bf16 v[224:239], v[72:75], v[84:87], v[224:239]
    ds_read_b64_tr_b16 a[154:155], v36 offset:2560
    s_lshl_b32 s42, s42, 11
    v_mfma_f32_32x32x16_bf16 v[176:191], v[76:79], v[80:83], v[176:191]
    ds_read_b64_tr_b16 v[100:101], v31 offset:36864
    ds_read_b64_tr_b16 v[102:103], v31 offset:37888
    buffer_load_dwordx4 v22, s[4:7], s73 offen offset:2048 lds
    s_lshl_b32 s81, s24, 12
    v_mfma_f32_32x32x16_bf16 v[240:255], v[76:79], v[84:87], v[240:255]
    ds_read_b64_tr_b16 a[156:157], v36 offset:2848
    s_waitcnt lgkmcnt(7)
    v_mfma_f32_32x32x16_bf16 v[128:143], v[88:91], v[104:107], v[128:143]
    ds_read_b128 v[80:83], v26 offset:16384
    ds_read_b64_tr_b16 v[64:65], v28 offset:40960
    buffer_load_dwordx4 v23, s[4:7], s73 offen offset:3072 lds
    v_bfe_u32 v14, v6, 1, 1
    v_mfma_f32_32x32x16_bf16 v[192:207], v[88:91], v[108:111], v[192:207]
    ds_read_b64_tr_b16 v[66:67], v28 offset:41984
    ds_read_b128 v[84:87], v26 offset:20480
    ds_read_b64_tr_b16 a[158:159], v36 offset:2816
    v_mfma_f32_32x32x16_bf16 v[144:159], v[92:95], v[104:107], v[144:159]
    s_add_u32 m0, s71, 49152
    s_add_u32 s74, s72, 688128
    buffer_load_dwordx4 v16, s[8:11], s74 offen offset:0 lds
    v_lshlrev_b32 v14, 2, v14
    v_xor_b32 v14, v14, v7
    v_mfma_f32_32x32x16_bf16 v[208:223], v[92:95], v[108:111], v[208:223]
    ds_read_b64_tr_b16 v[68:69], v29 offset:40960
    ds_read_b64_tr_b16 v[70:71], v29 offset:41984
    ds_read_b64_tr_b16 a[160:161], v36 offset:3104
    s_waitcnt lgkmcnt(9)
    v_mfma_f32_32x32x16_bf16 v[160:175], v[96:99], v[104:107], v[160:175]
    ds_read_b64_tr_b16 v[72:73], v30 offset:40960
    ds_read_b64_tr_b16 v[74:75], v30 offset:41984
    buffer_load_dwordx4 v17, s[8:11], s74 offen offset:1024 lds
    v_mfma_f32_32x32x16_bf16 v[224:239], v[96:99], v[108:111], v[224:239]
    ds_read_b64_tr_b16 a[162:163], v36 offset:3072
    ds_read_b64_tr_b16 a[164:165], v36 offset:3360
    v_lshlrev_b32 v14, 4, v14
    v_mfma_f32_32x32x16_bf16 v[176:191], v[100:103], v[104:107], v[176:191]
    ds_read_b64_tr_b16 v[76:77], v31 offset:40960
    ds_read_b64_tr_b16 v[78:79], v31 offset:41984
    buffer_load_dwordx4 v18, s[8:11], s74 offen offset:2048 lds
    v_lshl_add_u32 v60, v6, 10, v14
    v_mfma_f32_32x32x16_bf16 v[240:255], v[100:103], v[108:111], v[240:255]
    ds_read_b64_tr_b16 a[166:167], v36 offset:3328
    s_waitcnt lgkmcnt(8)
    v_mfma_f32_32x32x16_bf16 v[128:143], v[64:67], v[80:83], v[128:143]
    ds_read_b128 v[104:107], v27 offset:16384
    ds_read_b64_tr_b16 v[88:89], v28 offset:45056
    buffer_load_dwordx4 v19, s[8:11], s74 offen offset:3072 lds
    v_add_u32 v61, 7168, v60
    v_mfma_f32_32x32x16_bf16 v[192:207], v[64:67], v[84:87], v[192:207]
    ds_read_b64_tr_b16 v[90:91], v28 offset:46080
    ds_read_b128 v[108:111], v27 offset:20480
    v_add_u32 v62, 14336, v60
    v_mfma_f32_32x32x16_bf16 v[144:159], v[68:71], v[80:83], v[144:159]
    s_add_u32 m0, s71, 53248
    s_add_u32 s74, s72, 745472
    buffer_load_dwordx4 v16, s[8:11], s74 offen offset:0 lds
    ds_read_b64_tr_b16 a[168:169], v36 offset:3616
    v_add_u32 v63, 21504, v60
    v_mfma_f32_32x32x16_bf16 v[208:223], v[68:71], v[84:87], v[208:223]
    ds_read_b64_tr_b16 v[92:93], v29 offset:45056
    ds_read_b64_tr_b16 v[94:95], v29 offset:46080
    ds_read_b64_tr_b16 a[170:171], v36 offset:3584
    s_waitcnt lgkmcnt(9)
    v_mfma_f32_32x32x16_bf16 v[160:175], v[72:75], v[80:83], v[160:175]
    ds_read_b64_tr_b16 v[96:97], v30 offset:45056
    ds_read_b64_tr_b16 v[98:99], v30 offset:46080
    buffer_load_dwordx4 v17, s[8:11], s74 offen offset:1024 lds
    v_mfma_f32_32x32x16_bf16 v[224:239], v[72:75], v[84:87], v[224:239]
    ds_read_b64_tr_b16 a[172:173], v36 offset:3872
    v_and_b32 v14, 1, v3
    v_mfma_f32_32x32x16_bf16 v[176:191], v[76:79], v[80:83], v[176:191]
    ds_read_b64_tr_b16 v[100:101], v31 offset:45056
    ds_read_b64_tr_b16 v[102:103], v31 offset:46080
    buffer_load_dwordx4 v18, s[8:11], s74 offen offset:2048 lds
    v_lshl_add_u32 v14, v14, 2, v5
    v_mfma_f32_32x32x16_bf16 v[240:255], v[76:79], v[84:87], v[240:255]
    ds_read_b64_tr_b16 a[174:175], v36 offset:3840
    s_waitcnt lgkmcnt(7)
    v_mfma_f32_32x32x16_bf16 v[128:143], v[88:91], v[104:107], v[128:143]
    buffer_load_dwordx4 v19, s[8:11], s74 offen offset:3072 lds
    v_lshrrev_b32 v15, 1, v14
    v_and_b32 v14, 1, v14
    v_mfma_f32_32x32x16_bf16 v[192:207], v[88:91], v[108:111], v[192:207]
    s_waitcnt lgkmcnt(0)
    s_waitcnt vmcnt(12)
    s_barrier
    ds_read_b128 v[80:83], v24 offset:32768
    ds_read_b64_tr_b16 v[64:65], v32 offset:0
    v_mfma_f32_32x32x16_bf16 v[144:159], v[92:95], v[104:107], v[144:159]
    ds_read_b64_tr_b16 v[66:67], v32 offset:1024
    ds_read_b128 v[84:87], v24 offset:36864
    s_add_u32 m0, s70, 16384
    s_xor_b32 s73, s27, 512
    buffer_load_dwordx4 v20, s[4:7], s73 offen offset:0 lds
    v_mfma_f32_32x32x16_bf16 v[208:223], v[92:95], v[108:111], v[208:223]
    ds_read_b64_tr_b16 v[68:69], v33 offset:0
    ds_read_b64_tr_b16 v[70:71], v33 offset:1024
    v_lshlrev_b32 v14, 5, v14
    v_mfma_f32_32x32x16_bf16 v[160:175], v[96:99], v[104:107], v[160:175]
    ds_read_b64_tr_b16 v[72:73], v34 offset:0
    ds_read_b64_tr_b16 v[74:75], v34 offset:1024
    buffer_load_dwordx4 v21, s[4:7], s73 offen offset:1024 lds
    v_mfma_f32_32x32x16_bf16 v[224:239], v[96:99], v[108:111], v[224:239]
    ds_read_b64_tr_b16 v[76:77], v35 offset:0
    ds_read_b64_tr_b16 v[78:79], v35 offset:1024
    v_lshl_add_u32 v14, v15, 3, v14
    v_mfma_f32_32x32x16_bf16 v[176:191], v[100:103], v[104:107], v[176:191]
    v_lshl_add_u32 v15, v9, 3, v4
    v_mfma_f32_32x32x16_bf16 v[240:255], v[100:103], v[108:111], v[240:255]
    buffer_load_dwordx4 v22, s[4:7], s73 offen offset:2048 lds
    s_waitcnt lgkmcnt(4)
    v_mfma_f32_32x32x16_bf16 v[128:143], v[64:67], v[80:83], v[128:143]
    ds_read_b128 v[104:107], v25 offset:32768
    ds_read_b64_tr_b16 v[88:89], v32 offset:4096
    v_lshl_add_u32 v14, v15, 7, v14
    v_mfma_f32_32x32x16_bf16 v[192:207], v[64:67], v[84:87], v[192:207]
    ds_read_b64_tr_b16 v[90:91], v32 offset:5120
    ds_read_b128 v[108:111], v25 offset:36864
    v_lshrrev_b32 v15, 1, v4
    v_mfma_f32_32x32x16_bf16 v[144:159], v[68:71], v[80:83], v[144:159]
    buffer_load_dwordx4 v23, s[4:7], s73 offen offset:3072 lds
    v_mfma_f32_32x32x16_bf16 v[208:223], v[68:71], v[84:87], v[208:223]
    ds_read_b64_tr_b16 v[92:93], v33 offset:4096
    ds_read_b64_tr_b16 v[94:95], v33 offset:5120
    v_xor_b32 v15, s28, v15
    s_waitcnt lgkmcnt(6)
    v_mfma_f32_32x32x16_bf16 v[160:175], v[72:75], v[80:83], v[160:175]
    ds_read_b64_tr_b16 v[96:97], v34 offset:4096
    ds_read_b64_tr_b16 v[98:99], v34 offset:5120
    v_lshl_add_u32 v10, v15, 6, v14
    v_mfma_f32_32x32x16_bf16 v[224:239], v[72:75], v[84:87], v[224:239]
    s_add_u32 m0, s71, 81920
    s_add_u32 s74, s3, 0
    buffer_load_dwordx4 v16, s[8:11], s74 offen offset:0 lds
    v_mfma_f32_32x32x16_bf16 v[176:191], v[76:79], v[80:83], v[176:191]
    ds_read_b64_tr_b16 v[100:101], v35 offset:4096
    ds_read_b64_tr_b16 v[102:103], v35 offset:5120
    v_xor_b32 v11, 64, v10
    v_mfma_f32_32x32x16_bf16 v[240:255], v[76:79], v[84:87], v[240:255]
    buffer_load_dwordx4 v17, s[8:11], s74 offen offset:1024 lds
    s_waitcnt lgkmcnt(4)
    v_mfma_f32_32x32x16_bf16 v[128:143], v[88:91], v[104:107], v[128:143]
    ds_read_b128 v[80:83], v26 offset:32768
    ds_read_b64_tr_b16 v[64:65], v32 offset:8192
    v_add_u32 v10, s81, v10
    v_mfma_f32_32x32x16_bf16 v[192:207], v[88:91], v[108:111], v[192:207]
    ds_read_b64_tr_b16 v[66:67], v32 offset:9216
    ds_read_b128 v[84:87], v26 offset:36864
    v_add_u32 v11, s81, v11
    v_mfma_f32_32x32x16_bf16 v[144:159], v[92:95], v[104:107], v[144:159]
    buffer_load_dwordx4 v18, s[8:11], s74 offen offset:2048 lds
    v_mfma_f32_32x32x16_bf16 v[208:223], v[92:95], v[108:111], v[208:223]
    ds_read_b64_tr_b16 v[68:69], v33 offset:8192
    ds_read_b64_tr_b16 v[70:71], v33 offset:9216
    v_add_u32 v58, 0x10000, v10
    s_waitcnt lgkmcnt(6)
    v_mfma_f32_32x32x16_bf16 v[160:175], v[96:99], v[104:107], v[160:175]
    ds_read_b64_tr_b16 v[72:73], v34 offset:8192
    ds_read_b64_tr_b16 v[74:75], v34 offset:9216
    buffer_load_dwordx4 v19, s[8:11], s74 offen offset:3072 lds
    v_add_u32 v59, 0x10000, v11
    v_mfma_f32_32x32x16_bf16 v[224:239], v[96:99], v[108:111], v[224:239]
    v_mfma_f32_32x32x16_bf16 v[176:191], v[100:103], v[104:107], v[176:191]
    ds_read_b64_tr_b16 v[76:77], v35 offset:8192
    ds_read_b64_tr_b16 v[78:79], v35 offset:9216
    s_mul_i32 s88, s33, 224
    v_mfma_f32_32x32x16_bf16 v[240:255], v[100:103], v[108:111], v[240:255]
    s_add_u32 m0, s71, 86016
    s_add_u32 s74, s3, 57344
    buffer_load_dwordx4 v16, s[8:11], s74 offen offset:0 lds
    s_waitcnt lgkmcnt(4)
    v_mfma_f32_32x32x16_bf16 v[128:143], v[64:67], v[80:83], v[128:143]
    ds_read_b128 v[104:107], v27 offset:32768
    ds_read_b64_tr_b16 v[88:89], v32 offset:12288
    s_add_u32 s88, s88, s69
    v_mfma_f32_32x32x16_bf16 v[192:207], v[64:67], v[84:87], v[192:207]
    ds_read_b64_tr_b16 v[90:91], v32 offset:13312
    ds_read_b128 v[108:111], v27 offset:36864
    s_lshl_b32 s88, s88, 10
    v_mfma_f32_32x32x16_bf16 v[144:159], v[68:71], v[80:83], v[144:159]
    buffer_load_dwordx4 v17, s[8:11], s74 offen offset:1024 lds
    v_mfma_f32_32x32x16_bf16 v[208:223], v[68:71], v[84:87], v[208:223]
    ds_read_b64_tr_b16 v[92:93], v33 offset:12288
    ds_read_b64_tr_b16 v[94:95], v33 offset:13312
    s_add_u32 s88, s88, 65536
    s_waitcnt lgkmcnt(6)
    v_mfma_f32_32x32x16_bf16 v[160:175], v[72:75], v[80:83], v[160:175]
    ds_read_b64_tr_b16 v[96:97], v34 offset:12288
    ds_read_b64_tr_b16 v[98:99], v34 offset:13312
    buffer_load_dwordx4 v18, s[8:11], s74 offen offset:2048 lds
    s_add_u32 s89, s88, 14336
    v_mfma_f32_32x32x16_bf16 v[224:239], v[72:75], v[84:87], v[224:239]
    v_readfirstlane_b32 s35, v41
    s_nop 0
    s_cmp_eq_u32 s35, 0
    s_cbranch_scc1 L_slown0
L_backn0:
    v_mov_b32 v42, s35
    v_mfma_f32_32x32x16_bf16 v[176:191], v[76:79], v[80:83], v[176:191]
    ds_read_b64_tr_b16 v[100:101], v35 offset:12288
    ds_read_b64_tr_b16 v[102:103], v35 offset:13312
    s_sub_u32 s89, s89, s42
    v_mfma_f32_32x32x16_bf16 v[240:255], v[76:79], v[84:87], v[240:255]
    buffer_load_dwordx4 v19, s[8:11], s74 offen offset:3072 lds
    s_lshr_b32 s43, s87, 3
    s_lshl_b32 s43, s43, 11
    s_waitcnt lgkmcnt(4)
    v_mfma_f32_32x32x16_bf16 v[128:143], v[88:91], v[104:107], v[128:143]
    s_bfe_u32 s69, s87, 0x20001
    s_lshl_b32 s69, s69, 8
    s_add_u32 s43, s43, s69
    v_mfma_f32_32x32x16_bf16 v[192:207], v[88:91], v[108:111], v[192:207]
    s_waitcnt lgkmcnt(0)
    s_waitcnt vmcnt(12)
    s_barrier
    ds_read_b128 v[80:83], v24 offset:0
    ds_read_b64_tr_b16 v[64:65], v28 offset:0
    v_mfma_f32_32x32x16_bf16 v[144:159], v[92:95], v[104:107], v[144:159]
    ds_read_b64_tr_b16 v[66:67], v28 offset:1024
    ds_read_b128 v[84:87], v24 offset:4096
    s_add_u32 m0, s70, 32768
    s_xor_b32 s73, s27, 640
    buffer_load_dwordx4 v20, s[4:7], s73 offen offset:0 lds
    v_mfma_f32_32x32x16_bf16 v[208:223], v[92:95], v[108:111], v[208:223]
    ds_read_b64_tr_b16 v[68:69], v29 offset:0
    ds_read_b64_tr_b16 v[70:71], v29 offset:1024
    s_and_b32 s69, s87, 1
    s_lshl_b32 s69, s69, 5
    v_mfma_f32_32x32x16_bf16 v[160:175], v[96:99], v[104:107], v[160:175]
    ds_read_b64_tr_b16 v[72:73], v30 offset:0
    ds_read_b64_tr_b16 v[74:75], v30 offset:1024
    buffer_load_dwordx4 v21, s[4:7], s73 offen offset:1024 lds
    s_add_u32 s43, s43, s69
    v_mfma_f32_32x32x16_bf16 v[224:239], v[96:99], v[108:111], v[224:239]
    ds_read_b64_tr_b16 v[76:77], v31 offset:0
    ds_read_b64_tr_b16 v[78:79], v31 offset:1024
    s_lshl_b32 s69, s24, 19
    s_add_u32 s43, s43, s69
    v_mfma_f32_32x32x16_bf16 v[176:191], v[100:103], v[104:107], v[176:191]
    buffer_load_dwordx4 v22, s[4:7], s73 offen offset:2048 lds
    s_add_u32 s43, s43, 9437184
    v_mfma_f32_32x32x16_bf16 v[240:255], v[100:103], v[108:111], v[240:255]
    s_add_u32 s39, s43, 261120
    s_lshl_b32 s44, s24, 11
    s_waitcnt lgkmcnt(4)
    v_mfma_f32_32x32x16_bf16 v[128:143], v[64:67], v[80:83], v[128:143]
    ds_read_b128 v[104:107], v25 offset:0
    ds_read_b64_tr_b16 v[88:89], v28 offset:4096
    buffer_load_dwordx4 v23, s[4:7], s73 offen offset:3072 lds
    s_add_u32 s44, s44, 148480
    v_mfma_f32_32x32x16_bf16 v[192:207], v[64:67], v[84:87], v[192:207]
    ds_read_b64_tr_b16 v[90:91], v28 offset:5120
    ds_read_b128 v[108:111], v25 offset:4096
    v_bfe_u32 v14, v1, 1, 2
    v_mfma_f32_32x32x16_bf16 v[144:159], v[68:71], v[80:83], v[144:159]
    s_add_u32 m0, s81, 32768
    s_nop 0
    buffer_load_dwordx4 v60, s[16:19], s80 offen lds
    v_lshlrev_b32 v14, 6, v14
    v_and_b32 v15, 1, v6
    v_mfma_f32_32x32x16_bf16 v[208:223], v[68:71], v[84:87], v[208:223]
    ds_read_b64_tr_b16 v[92:93], v29 offset:4096
    ds_read_b64_tr_b16 v[94:95], v29 offset:5120
    v_lshl_add_u32 v14, v15, 10, v14
    s_waitcnt lgkmcnt(6)
    v_mfma_f32_32x32x16_bf16 v[160:175], v[72:75], v[80:83], v[160:175]
    ds_read_b64_tr_b16 v[96:97], v30 offset:4096
    ds_read_b64_tr_b16 v[98:99], v30 offset:5120
    buffer_load_dwordx4 v61, s[16:19], s80 offen offset:1024 lds
    v_lshl_add_u32 v14, v3, 16, v14
    v_mfma_f32_32x32x16_bf16 v[224:239], v[72:75], v[84:87], v[224:239]
    v_and_b32 v15, 1, v1
    v_lshl_add_u32 v15, v15, 4, v14
    v_mfma_f32_32x32x16_bf16 v[176:191], v[76:79], v[80:83], v[176:191]
    ds_read_b64_tr_b16 v[100:101], v31 offset:4096
    ds_read_b64_tr_b16 v[102:103], v31 offset:5120
    buffer_load_dwordx4 v62, s[16:19], s80 offen offset:2048 lds
    s_lshl_b32 s68, s28, 8
    v_mfma_f32_32x32x16_bf16 v[240:255], v[76:79], v[84:87], v[240:255]
    s_sub_u32 s68, 147840, s68
    s_lshl_b32 s69, s29, 4
    s_add_u32 s68, s68, s69
    s_waitcnt lgkmcnt(4)
    v_mfma_f32_32x32x16_bf16 v[128:143], v[88:91], v[104:107], v[128:143]
    ds_read_b128 v[80:83], v26 offset:0
    ds_read_b64_tr_b16 v[64:65], v28 offset:8192
    buffer_load_dwordx4 v63, s[16:19], s80 offen offset:3072 lds
    s_add_u32 s80, s80, 32768
    v_mfma_f32_32x32x16_bf16 v[192:207], v[88:91], v[108:111], v[192:207]
    ds_read_b64_tr_b16 v[66:67], v28 offset:9216
    ds_read_b128 v[84:87], v26 offset:4096
    v_lshlrev_b32 v37, 5, v8
    v_mfma_f32_32x32x16_bf16 v[144:159], v[92:95], v[104:107], v[144:159]
    s_add_u32 m0, s71, 0
    s_add_u32 s74, s3, 229376
    buffer_load_dwordx4 v16, s[8:11], s74 offen offset:0 lds
    v_lshl_add_u32 v37, v9, 7, v37
    v_mfma_f32_32x32x16_bf16 v[208:223], v[92:95], v[108:111], v[208:223]
    ds_read_b64_tr_b16 v[68:69], v29 offset:8192
    ds_read_b64_tr_b16 v[70:71], v29 offset:9216
    v_add_u32 v37, s68, v37
    s_lshl_b32 s38, s24, 8
    s_waitcnt lgkmcnt(6)
    v_mfma_f32_32x32x16_bf16 v[160:175], v[96:99], v[104:107], v[160:175]
    ds_read_b64_tr_b16 v[72:73], v30 offset:8192
    ds_read_b64_tr_b16 v[74:75], v30 offset:9216
    buffer_load_dwordx4 v17, s[8:11], s74 offen offset:1024 lds
    s_add_u32 s38, s38, 147456
    v_mfma_f32_32x32x16_bf16 v[224:239], v[96:99], v[108:111], v[224:239]
    s_lshl_b32 s69, s25, 1
    v_mfma_f32_32x32x16_bf16 v[176:191], v[100:103], v[104:107], v[176:191]
    ds_read_b64_tr_b16 v[76:77], v31 offset:8192
    ds_read_b64_tr_b16 v[78:79], v31 offset:9216
    buffer_load_dwordx4 v18, s[8:11], s74 offen offset:2048 lds
    s_add_u32 s69, s69, s29
    v_mfma_f32_32x32x16_bf16 v[240:255], v[100:103], v[108:111], v[240:255]
    s_mul_i32 s45, s69, 224
    s_lshl_b32 s68, s26, 1
    s_waitcnt lgkmcnt(4)
    v_mfma_f32_32x32x16_bf16 v[128:143], v[64:67], v[80:83], v[128:143]
    ds_read_b128 v[104:107], v27 offset:0
    ds_read_b64_tr_b16 v[88:89], v28 offset:12288
    buffer_load_dwordx4 v19, s[8:11], s74 offen offset:3072 lds
    s_add_u32 s68, s68, s28
    v_mfma_f32_32x32x16_bf16 v[192:207], v[64:67], v[84:87], v[192:207]
    ds_read_b64_tr_b16 v[90:91], v28 offset:13312
    ds_read_b128 v[108:111], v27 offset:4096
    s_mul_i32 s52, s68, 37
    s_lshr_b32 s52, s52, 8
    v_mfma_f32_32x32x16_bf16 v[144:159], v[68:71], v[80:83], v[144:159]
    s_add_u32 m0, s71, 4096
    s_add_u32 s74, s3, 286720
    buffer_load_dwordx4 v16, s[8:11], s74 offen offset:0 lds
    s_mul_i32 s52, s52, 100
    v_mfma_f32_32x32x16_bf16 v[208:223], v[68:71], v[84:87], v[208:223]
    ds_read_b64_tr_b16 v[92:93], v29 offset:12288
    ds_read_b64_tr_b16 v[94:95], v29 offset:13312
    s_lshl_b32 s51, s69, 9
    s_waitcnt lgkmcnt(6)
    v_mfma_f32_32x32x16_bf16 v[160:175], v[72:75], v[80:83], v[160:175]
    ds_read_b64_tr_b16 v[96:97], v30 offset:12288
    ds_read_b64_tr_b16 v[98:99], v30 offset:13312
    buffer_load_dwordx4 v17, s[8:11], s74 offen offset:1024 lds
    s_add_u32 s51, s51, s52
    v_mfma_f32_32x32x16_bf16 v[224:239], v[72:75], v[84:87], v[224:239]
    s_lshl_b32 s52, s68, 2
    s_add_u32 s51, s51, s52
    s_cmp_lg_u32 s75, 0
    s_cselect_b32 s51, 0x4000, s51
    v_mfma_f32_32x32x16_bf16 v[176:191], v[76:79], v[80:83], v[176:191]
    ds_read_b64_tr_b16 v[100:101], v31 offset:12288
    ds_read_b64_tr_b16 v[102:103], v31 offset:13312
    buffer_load_dwordx4 v18, s[8:11], s74 offen offset:2048 lds
    v_mfma_f32_32x32x16_bf16 v[240:255], v[76:79], v[84:87], v[240:255]
    s_add_u32 s51, s51, 15990784
    s_lshl_b32 s68, s68, 2
    s_waitcnt lgkmcnt(4)
    v_mfma_f32_32x32x16_bf16 v[128:143], v[88:91], v[104:107], v[128:143]
    buffer_load_dwordx4 v19, s[8:11], s74 offen offset:3072 lds
    s_add_u32 s45, s45, s68
    s_lshl_b32 s45, s45, 10
    s_add_u32 s45, s45, 65536
    v_mfma_f32_32x32x16_bf16 v[192:207], v[88:91], v[108:111], v[192:207]
    s_waitcnt lgkmcnt(0)
    s_waitcnt vmcnt(16)
    s_barrier
    ds_read_b128 v[80:83], v24 offset:16384
    ds_read_b64_tr_b16 v[64:65], v28 offset:32768
    v_mfma_f32_32x32x16_bf16 v[144:159], v[92:95], v[104:107], v[144:159]
    ds_read_b64_tr_b16 v[66:67], v28 offset:33792
    ds_read_b128 v[84:87], v24 offset:20480
    s_add_u32 m0, s70, 0
    s_xor_b32 s73, s27, 768
    buffer_load_dwordx4 v20, s[4:7], s73 offen offset:0 lds
    v_mfma_f32_32x32x16_bf16 v[208:223], v[92:95], v[108:111], v[208:223]
    ds_read_b64_tr_b16 v[68:69], v29 offset:32768
    ds_read_b64_tr_b16 v[70:71], v29 offset:33792
    s_add_u32 s45, s45, s75
    s_add_u32 s50, s45, 114688
    v_mfma_f32_32x32x16_bf16 v[160:175], v[96:99], v[104:107], v[160:175]
    ds_read_b64_tr_b16 v[72:73], v30 offset:32768
    ds_read_b64_tr_b16 v[74:75], v30 offset:33792
    buffer_load_dwordx4 v21, s[4:7], s73 offen offset:1024 lds
    s_lshl_b32 s52, s33, 2
    v_mfma_f32_32x32x16_bf16 v[224:239], v[96:99], v[108:111], v[224:239]
    ds_read_b64_tr_b16 v[76:77], v31 offset:32768
    ds_read_b64_tr_b16 v[78:79], v31 offset:33792
    s_add_u32 s52, s52, s24
    s_lshl_b32 s52, s52, 7
    v_mfma_f32_32x32x16_bf16 v[176:191], v[100:103], v[104:107], v[176:191]
    s_add_u32 s52, s52, 15990784
    v_mfma_f32_32x32x16_bf16 v[240:255], v[100:103], v[108:111], v[240:255]
    buffer_load_dwordx4 v22, s[4:7], s73 offen offset:2048 lds
    s_lshl_b32 s53, s24, 13
    s_add_u32 s53, s53, 114688
    s_waitcnt lgkmcnt(4)
    v_mfma_f32_32x32x16_bf16 v[128:143], v[64:67], v[80:83], v[128:143]
    ds_read_b128 v[104:107], v25 offset:16384
    ds_read_b64_tr_b16 v[88:89], v28 offset:36864
    s_lshl_b32 s54, s24, 10
    v_mfma_f32_32x32x16_bf16 v[192:207], v[64:67], v[84:87], v[192:207]
    ds_read_b64_tr_b16 v[90:91], v28 offset:37888
    ds_read_b128 v[108:111], v25 offset:20480
    s_add_u32 s54, s54, 114688
    v_mfma_f32_32x32x16_bf16 v[144:159], v[68:71], v[80:83], v[144:159]
    buffer_load_dwordx4 v23, s[4:7], s73 offen offset:3072 lds
    s_lshl_b32 s55, s87, 14
    s_lshl_b32 s69, s24, 11
    v_mfma_f32_32x32x16_bf16 v[208:223], v[68:71], v[84:87], v[208:223]
    ds_read_b64_tr_b16 v[92:93], v29 offset:36864
    ds_read_b64_tr_b16 v[94:95], v29 offset:37888
    s_add_u32 s55, s55, s69
    s_waitcnt lgkmcnt(6)
    v_mfma_f32_32x32x16_bf16 v[160:175], v[72:75], v[80:83], v[160:175]
    ds_read_b64_tr_b16 v[96:97], v30 offset:36864
    ds_read_b64_tr_b16 v[98:99], v30 offset:37888
    s_add_u32 s55, s55, 11534336
    v_mfma_f32_32x32x16_bf16 v[224:239], v[72:75], v[84:87], v[224:239]
    s_add_u32 m0, s71, 49152
    s_add_u32 s74, s3, 458752
    buffer_load_dwordx4 v16, s[8:11], s74 offen offset:0 lds
    s_add_u32 s40, s55, 8192
    s_lshl_b32 s56, s34, 5
    v_mfma_f32_32x32x16_bf16 v[176:191], v[76:79], v[80:83], v[176:191]
    ds_read_b64_tr_b16 v[100:101], v31 offset:36864
    ds_read_b64_tr_b16 v[102:103], v31 offset:37888
    s_lshl_b32 s68, s28, 4
    v_mfma_f32_32x32x16_bf16 v[240:255], v[76:79], v[84:87], v[240:255]
    buffer_load_dwordx4 v17, s[8:11], s74 offen offset:1024 lds
    s_add_u32 s56, s56, s68
    s_lshl_b32 s56, s56, 14
    s_lshl_b32 s68, s79, 3
    s_waitcnt lgkmcnt(4)
    v_mfma_f32_32x32x16_bf16 v[128:143], v[88:91], v[104:107], v[128:143]
    ds_read_b128 v[80:83], v26 offset:16384
    ds_read_b64_tr_b16 v[64:65], v28 offset:40960
    s_waitcnt vmcnt(14)
    ds_read_b64_tr_b16 a[0:1], v10 offset:32768
    v_mfma_f32_32x32x16_bf16 v[192:207], v[88:91], v[108:111], v[192:207]
    ds_read_b64_tr_b16 v[66:67], v28 offset:41984
    ds_read_b128 v[84:87], v26 offset:20480
    ds_read_b64_tr_b16 a[2:3], v10 offset:33280
    s_add_u32 s56, s56, s68
    v_mfma_f32_32x32x16_bf16 v[144:159], v[92:95], v[104:107], v[144:159]
    buffer_load_dwordx4 v18, s[8:11], s74 offen offset:2048 lds
    s_add_u32 s56, s56, 11534336
    s_lshl_b32 s57, s79, 3
    s_add_u32 s57, s57, 15728640
    v_mfma_f32_32x32x16_bf16 v[208:223], v[92:95], v[108:111], v[208:223]
    ds_read_b64_tr_b16 v[68:69], v29 offset:40960
    ds_read_b64_tr_b16 v[70:71], v29 offset:41984
    ds_read_b64_tr_b16 a[4:5], v11 offset:32768
    s_waitcnt lgkmcnt(9)
    v_mfma_f32_32x32x16_bf16 v[160:175], v[96:99], v[104:107], v[160:175]
    ds_read_b64_tr_b16 v[72:73], v30 offset:40960
    ds_read_b64_tr_b16 v[74:75], v30 offset:41984
    buffer_load_dwordx4 v19, s[8:11], s74 offen offset:3072 lds
    s_lshl_b32 s84, s79, 10
    v_mfma_f32_32x32x16_bf16 v[224:239], v[96:99], v[108:111], v[224:239]
    ds_read_b64_tr_b16 a[6:7], v11 offset:33280
    s_lshl_b32 s68, s34, 7
    v_mfma_f32_32x32x16_bf16 v[176:191], v[100:103], v[104:107], v[176:191]
    ds_read_b64_tr_b16 v[76:77], v31 offset:40960
    ds_read_b64_tr_b16 v[78:79], v31 offset:41984
    s_add_u32 s84, s84, s68
    s_lshl_b32 s68, s28, 6
    s_add_u32 s84, s84, s68
    v_mfma_f32_32x32x16_bf16 v[240:255], v[100:103], v[108:111], v[240:255]
    s_add_u32 m0, s71, 53248
    s_add_u32 s74, s3, 516096
    buffer_load_dwordx4 v16, s[8:11], s74 offen offset:0 lds
    ds_read_b64_tr_b16 a[8:9], v10 offset:34816
    s_waitcnt lgkmcnt(7)
    v_mfma_f32_32x32x16_bf16 v[128:143], v[64:67], v[80:83], v[128:143]
    ds_read_b128 v[104:107], v27 offset:16384
    ds_read_b64_tr_b16 v[88:89], v28 offset:45056
    ds_read_b64_tr_b16 a[10:11], v10 offset:35328
    s_mov_b32 s48, 0xbfb8aa3b
    v_mfma_f32_32x32x16_bf16 v[192:207], v[64:67], v[84:87], v[192:207]
    ds_read_b64_tr_b16 v[90:91], v28 offset:46080
    ds_read_b128 v[108:111], v27 offset:20480
    s_mov_b32 s49, 0xbfb8aa3b
    s_mul_i32 s68, s29, 114688
    v_mfma_f32_32x32x16_bf16 v[144:159], v[68:71], v[80:83], v[144:159]
    buffer_load_dwordx4 v17, s[8:11], s74 offen offset:1024 lds
    ds_read_b64_tr_b16 a[12:13], v11 offset:34816
    s_sub_u32 s69, 114688, s68
    v_add_u32 v12, s68, v38
    v_mfma_f32_32x32x16_bf16 v[208:223], v[68:71], v[84:87], v[208:223]
    ds_read_b64_tr_b16 v[92:93], v29 offset:45056
    ds_read_b64_tr_b16 v[94:95], v29 offset:46080
    ds_read_b64_tr_b16 a[14:15], v11 offset:35328
    s_waitcnt lgkmcnt(10)
    v_mfma_f32_32x32x16_bf16 v[160:175], v[72:75], v[80:83], v[160:175]
    ds_read_b64_tr_b16 v[96:97], v30 offset:45056
    ds_read_b64_tr_b16 v[98:99], v30 offset:46080
    buffer_load_dwordx4 v18, s[8:11], s74 offen offset:2048 lds
    v_add_u32 v13, s69, v38
    v_mfma_f32_32x32x16_bf16 v[224:239], v[72:75], v[84:87], v[224:239]
    v_lshlrev_b32 v0, 7, v7
    v_lshlrev_b32 v3, 3, v8
    v_mfma_f32_32x32x16_bf16 v[176:191], v[76:79], v[80:83], v[176:191]
    ds_read_b64_tr_b16 v[100:101], v31 offset:45056
    ds_read_b64_tr_b16 v[102:103], v31 offset:46080
    v_lshl_add_u32 v3, v9, 17, v3
    v_mfma_f32_32x32x16_bf16 v[240:255], v[76:79], v[84:87], v[240:255]
    buffer_load_dwordx4 v19, s[8:11], s74 offen offset:3072 lds
    v_lshlrev_b32 v4, 3, v8
    v_lshlrev_b32 v5, 10, v8
    s_waitcnt lgkmcnt(5)
    v_mfma_f32_32x32x16_bf16 v[128:143], v[88:91], v[104:107], v[128:143]
    v_lshl_add_u32 v5, v9, 5, v5
    v_mov_b32 v6, 0x40000000
    v_mfma_f32_32x32x16_bf16 v[192:207], v[88:91], v[108:111], v[192:207]
    s_waitcnt lgkmcnt(0)
    s_waitcnt vmcnt(12)
    s_barrier
    ds_read_b128 v[80:83], v24 offset:32768
    ds_read_b64_tr_b16 v[64:65], v32 offset:0
    v_mfma_f32_32x32x16_bf16 v[144:159], v[92:95], v[104:107], v[144:159]
    ds_read_b64_tr_b16 v[66:67], v32 offset:1024
    ds_read_b128 v[84:87], v24 offset:36864
    s_add_u32 m0, s70, 16384
    s_xor_b32 s73, s27, 896
    buffer_load_dwordx4 v20, s[4:7], s73 offen offset:0 lds
    v_mfma_f32_32x32x16_bf16 v[208:223], v[92:95], v[108:111], v[208:223]
    ds_read_b64_tr_b16 v[68:69], v33 offset:0
    ds_read_b64_tr_b16 v[70:71], v33 offset:1024
    v_mfma_f32_32x32x16_bf16 v[160:175], v[96:99], v[104:107], v[160:175]
    ds_read_b64_tr_b16 v[72:73], v34 offset:0
    ds_read_b64_tr_b16 v[74:75], v34 offset:1024
    buffer_load_dwordx4 v21, s[4:7], s73 offen offset:1024 lds
    v_mfma_f32_32x32x16_bf16 v[224:239], v[96:99], v[108:111], v[224:239]
    ds_read_b64_tr_b16 v[76:77], v35 offset:0
    ds_read_b64_tr_b16 v[78:79], v35 offset:1024
    v_mfma_f32_32x32x16_bf16 v[176:191], v[100:103], v[104:107], v[176:191]
    buffer_load_dwordx4 v22, s[4:7], s73 offen offset:2048 lds
    v_mfma_f32_32x32x16_bf16 v[240:255], v[100:103], v[108:111], v[240:255]
    s_waitcnt lgkmcnt(4)
    v_mfma_f32_32x32x16_bf16 v[128:143], v[64:67], v[80:83], v[128:143]
    ds_read_b128 v[104:107], v25 offset:32768
    ds_read_b64_tr_b16 v[88:89], v32 offset:4096
    buffer_load_dwordx4 v23, s[4:7], s73 offen offset:3072 lds
    v_mfma_f32_32x32x16_bf16 v[192:207], v[64:67], v[84:87], v[192:207]
    ds_read_b64_tr_b16 v[90:91], v32 offset:5120
    ds_read_b128 v[108:111], v25 offset:36864
    v_mfma_f32_32x32x16_bf16 v[144:159], v[68:71], v[80:83], v[144:159]
    s_add_u32 m0, s81, 32768
    s_nop 0
    buffer_load_dwordx4 v60, s[16:19], s80 offen lds
    buffer_load_dword v44, v0, s[12:15], s41 offen sc1
    v_mfma_f32_32x32x16_bf16 v[208:223], v[68:71], v[84:87], v[208:223]
    ds_read_b64_tr_b16 v[92:93], v33 offset:4096
    ds_read_b64_tr_b16 v[94:95], v33 offset:5120
    s_waitcnt lgkmcnt(6)
    v_mfma_f32_32x32x16_bf16 v[160:175], v[72:75], v[80:83], v[160:175]
    ds_read_b64_tr_b16 v[96:97], v34 offset:4096
    ds_read_b64_tr_b16 v[98:99], v34 offset:5120
    buffer_load_dwordx4 v61, s[16:19], s80 offen offset:1024 lds
    v_mfma_f32_32x32x16_bf16 v[224:239], v[72:75], v[84:87], v[224:239]
    v_mfma_f32_32x32x16_bf16 v[176:191], v[76:79], v[80:83], v[176:191]
    ds_read_b64_tr_b16 v[100:101], v35 offset:4096
    ds_read_b64_tr_b16 v[102:103], v35 offset:5120
    buffer_load_dwordx4 v62, s[16:19], s80 offen offset:2048 lds
    v_mfma_f32_32x32x16_bf16 v[240:255], v[76:79], v[84:87], v[240:255]
    s_waitcnt lgkmcnt(4)
    v_mfma_f32_32x32x16_bf16 v[128:143], v[88:91], v[104:107], v[128:143]
    ds_read_b128 v[80:83], v26 offset:32768
    ds_read_b64_tr_b16 v[64:65], v32 offset:8192
    buffer_load_dwordx4 v63, s[16:19], s80 offen offset:3072 lds
    s_add_u32 s80, s80, 32768
    v_mfma_f32_32x32x16_bf16 v[192:207], v[88:91], v[108:111], v[192:207]
    ds_read_b64_tr_b16 v[66:67], v32 offset:9216
    ds_read_b128 v[84:87], v26 offset:36864
    v_mfma_f32_32x32x16_bf16 v[144:159], v[92:95], v[104:107], v[144:159]
    s_add_u32 m0, s71, 81920
    s_add_u32 s74, s3, 688128
    buffer_load_dwordx4 v16, s[8:11], s74 offen offset:0 lds
    v_mfma_f32_32x32x16_bf16 v[208:223], v[92:95], v[108:111], v[208:223]
    ds_read_b64_tr_b16 v[68:69], v33 offset:8192
    ds_read_b64_tr_b16 v[70:71], v33 offset:9216
    s_waitcnt lgkmcnt(6)
    v_mfma_f32_32x32x16_bf16 v[160:175], v[96:99], v[104:107], v[160:175]
    ds_read_b64_tr_b16 v[72:73], v34 offset:8192
    ds_read_b64_tr_b16 v[74:75], v34 offset:9216
    buffer_load_dwordx4 v17, s[8:11], s74 offen offset:1024 lds
    v_mfma_f32_32x32x16_bf16 v[224:239], v[96:99], v[108:111], v[224:239]
    v_mfma_f32_32x32x16_bf16 v[176:191], v[100:103], v[104:107], v[176:191]
    ds_read_b64_tr_b16 v[76:77], v35 offset:8192
    ds_read_b64_tr_b16 v[78:79], v35 offset:9216
    buffer_load_dwordx4 v18, s[8:11], s74 offen offset:2048 lds
    v_mfma_f32_32x32x16_bf16 v[240:255], v[100:103], v[108:111], v[240:255]
    s_waitcnt lgkmcnt(4)
    v_mfma_f32_32x32x16_bf16 v[128:143], v[64:67], v[80:83], v[128:143]
    ds_read_b128 v[104:107], v27 offset:32768
    ds_read_b64_tr_b16 v[88:89], v32 offset:12288
    buffer_load_dwordx4 v19, s[8:11], s74 offen offset:3072 lds
    v_mfma_f32_32x32x16_bf16 v[192:207], v[64:67], v[84:87], v[192:207]
    ds_read_b64_tr_b16 v[90:91], v32 offset:13312
    ds_read_b128 v[108:111], v27 offset:36864
    v_mfma_f32_32x32x16_bf16 v[144:159], v[68:71], v[80:83], v[144:159]
    s_add_u32 m0, s71, 86016
    s_add_u32 s74, s3, 745472
    buffer_load_dwordx4 v16, s[8:11], s74 offen offset:0 lds
    v_mfma_f32_32x32x16_bf16 v[208:223], v[68:71], v[84:87], v[208:223]
    ds_read_b64_tr_b16 v[92:93], v33 offset:12288
    ds_read_b64_tr_b16 v[94:95], v33 offset:13312
    s_waitcnt lgkmcnt(6)
    v_mfma_f32_32x32x16_bf16 v[160:175], v[72:75], v[80:83], v[160:175]
    ds_read_b64_tr_b16 v[96:97], v34 offset:12288
    ds_read_b64_tr_b16 v[98:99], v34 offset:13312
    buffer_load_dwordx4 v17, s[8:11], s74 offen offset:1024 lds
    v_mfma_f32_32x32x16_bf16 v[224:239], v[72:75], v[84:87], v[224:239]
    v_mfma_f32_32x32x16_bf16 v[176:191], v[76:79], v[80:83], v[176:191]
    ds_read_b64_tr_b16 v[100:101], v35 offset:12288
    ds_read_b64_tr_b16 v[102:103], v35 offset:13312
    buffer_load_dwordx4 v18, s[8:11], s74 offen offset:2048 lds
    v_mfma_f32_32x32x16_bf16 v[240:255], v[76:79], v[84:87], v[240:255]
    s_waitcnt lgkmcnt(4)
    v_mfma_f32_32x32x16_bf16 v[128:143], v[88:91], v[104:107], v[128:143]
    buffer_load_dwordx4 v19, s[8:11], s74 offen offset:3072 lds
    s_waitcnt vmcnt(11)
    v_cmp_ne_u32 vcc, s35, v44
    s_cbranch_vccnz L_slow0
L_back0:
    v_mfma_f32_32x32x16_bf16 v[192:207], v[88:91], v[108:111], v[192:207]
    s_waitcnt lgkmcnt(0)
    s_barrier
    ds_read_b128 v[80:83], v24 offset:0
    ds_read_b64_tr_b16 v[64:65], v28 offset:0
    v_mfma_f32_32x32x16_bf16 v[144:159], v[92:95], v[104:107], v[144:159]
    ds_read_b64_tr_b16 v[66:67], v28 offset:1024
    ds_read_b128 v[84:87], v24 offset:4096
    s_mov_b32 m0, s38
    s_nop 0
    buffer_load_dword v6, s[12:15], 0 offen lds
    v_mfma_f32_32x32x16_bf16 v[208:223], v[92:95], v[108:111], v[208:223]
    ds_read_b64_tr_b16 v[68:69], v29 offset:0
    ds_read_b64_tr_b16 v[70:71], v29 offset:1024
    v_mfma_f32_32x32x16_bf16 v[160:175], v[96:99], v[104:107], v[160:175]
    ds_read_b64_tr_b16 v[72:73], v30 offset:0
    ds_read_b64_tr_b16 v[74:75], v30 offset:1024
    s_mov_b32 m0, s44
    s_nop 0
    buffer_load_dwordx4 v15, s[12:15], s43 offen sc1 lds
    v_mfma_f32_32x32x16_bf16 v[224:239], v[96:99], v[108:111], v[224:239]
    ds_read_b64_tr_b16 v[76:77], v31 offset:0
    ds_read_b64_tr_b16 v[78:79], v31 offset:1024
    v_mfma_f32_32x32x16_bf16 v[176:191], v[100:103], v[104:107], v[176:191]
    buffer_load_dwordx4 v15, s[12:15], s39 offen offset:1024 sc1 lds
    v_mfma_f32_32x32x16_bf16 v[240:255], v[100:103], v[108:111], v[240:255]
    s_waitcnt lgkmcnt(4)
    v_mfma_f32_32x32x16_bf16 v[128:143], v[64:67], v[80:83], v[128:143]
    ds_read_b128 v[104:107], v25 offset:0
    ds_read_b64_tr_b16 v[88:89], v28 offset:4096
    v_mfma_f32_32x32x16_bf16 v[192:207], v[64:67], v[84:87], v[192:207]
    ds_read_b64_tr_b16 v[90:91], v28 offset:5120
    ds_read_b128 v[108:111], v25 offset:4096
    v_mfma_f32_32x32x16_bf16 v[144:159], v[68:71], v[80:83], v[144:159]
    s_add_u32 m0, s81, 0
    s_nop 0
    buffer_load_dwordx4 v60, s[16:19], s80 offen lds
    v_mfma_f32_32x32x16_bf16 v[208:223], v[68:71], v[84:87], v[208:223]
    ds_read_b64_tr_b16 v[92:93], v29 offset:4096
    ds_read_b64_tr_b16 v[94:95], v29 offset:5120
    s_waitcnt lgkmcnt(6)
    v_mfma_f32_32x32x16_bf16 v[160:175], v[72:75], v[80:83], v[160:175]
    ds_read_b64_tr_b16 v[96:97], v30 offset:4096
    ds_read_b64_tr_b16 v[98:99], v30 offset:5120
    buffer_load_dwordx4 v61, s[16:19], s80 offen offset:1024 lds
    v_mfma_f32_32x32x16_bf16 v[224:239], v[72:75], v[84:87], v[224:239]
    v_accvgpr_read_b32 v14, a252
    v_mfma_f32_32x32x16_bf16 v[176:191], v[76:79], v[80:83], v[176:191]
    ds_read_b64_tr_b16 v[100:101], v31 offset:4096
    ds_read_b64_tr_b16 v[102:103], v31 offset:5120
    v_mfma_f32_32x32x16_bf16 v[240:255], v[76:79], v[84:87], v[240:255]
    buffer_load_dwordx4 v62, s[16:19], s80 offen offset:2048 lds
    global_load_dword a254, v14, s[66:67]
    s_waitcnt lgkmcnt(4)
    v_mfma_f32_32x32x16_bf16 v[128:143], v[88:91], v[104:107], v[128:143]
    ds_read_b128 v[80:83], v26 offset:0
    ds_read_b64_tr_b16 v[64:65], v28 offset:8192
    s_waitcnt vmcnt(15)
    ds_read_b64_tr_b16 a[16:17], v10 offset:32768
    v_mfma_f32_32x32x16_bf16 v[192:207], v[88:91], v[108:111], v[192:207]
    ds_read_b64_tr_b16 v[66:67], v28 offset:9216
    ds_read_b128 v[84:87], v26 offset:4096
    ds_read_b64_tr_b16 a[18:19], v10 offset:33280
    v_mfma_f32_32x32x16_bf16 v[144:159], v[92:95], v[104:107], v[144:159]
    buffer_load_dwordx4 v63, s[16:19], s80 offen offset:3072 lds
    s_add_u32 s80, s80, 32768
    v_mfma_f32_32x32x16_bf16 v[208:223], v[92:95], v[108:111], v[208:223]
    ds_read_b64_tr_b16 v[68:69], v29 offset:8192
    ds_read_b64_tr_b16 v[70:71], v29 offset:9216
    ds_read_b64_tr_b16 a[20:21], v11 offset:32768
    s_waitcnt lgkmcnt(9)
    v_mfma_f32_32x32x16_bf16 v[160:175], v[96:99], v[104:107], v[160:175]
    ds_read_b64_tr_b16 v[72:73], v30 offset:8192
    ds_read_b64_tr_b16 v[74:75], v30 offset:9216
    v_mfma_f32_32x32x16_bf16 v[224:239], v[96:99], v[108:111], v[224:239]
    s_add_u32 m0, s81, 16384
    s_nop 0
    buffer_load_dwordx4 v60, s[16:19], s80 offen lds
    ds_read_b64_tr_b16 a[22:23], v11 offset:33280
    v_mfma_f32_32x32x16_bf16 v[176:191], v[100:103], v[104:107], v[176:191]
    ds_read_b64_tr_b16 v[76:77], v31 offset:8192
    ds_read_b64_tr_b16 v[78:79], v31 offset:9216
    v_mfma_f32_32x32x16_bf16 v[240:255], v[100:103], v[108:111], v[240:255]
    ds_read_b64_tr_b16 a[24:25], v10 offset:34816
    ds_read_b64_tr_b16 a[26:27], v10 offset:35328
    s_waitcnt lgkmcnt(8)
    v_mfma_f32_32x32x16_bf16 v[128:143], v[64:67], v[80:83], v[128:143]
    ds_read_b128 v[104:107], v27 offset:0
    ds_read_b64_tr_b16 v[88:89], v28 offset:12288
    buffer_load_dwordx4 v61, s[16:19], s80 offen offset:1024 lds
    v_mfma_f32_32x32x16_bf16 v[192:207], v[64:67], v[84:87], v[192:207]
    ds_read_b64_tr_b16 v[90:91], v28 offset:13312
    ds_read_b128 v[108:111], v27 offset:4096
    v_mfma_f32_32x32x16_bf16 v[144:159], v[68:71], v[80:83], v[144:159]
    ds_read_b64_tr_b16 a[28:29], v11 offset:34816
    v_mfma_f32_32x32x16_bf16 v[208:223], v[68:71], v[84:87], v[208:223]
    ds_read_b64_tr_b16 v[92:93], v29 offset:12288
    ds_read_b64_tr_b16 v[94:95], v29 offset:13312
    buffer_load_dwordx4 v62, s[16:19], s80 offen offset:2048 lds
    s_waitcnt lgkmcnt(9)
    v_mfma_f32_32x32x16_bf16 v[160:175], v[72:75], v[80:83], v[160:175]
    ds_read_b64_tr_b16 v[96:97], v30 offset:12288
    ds_read_b64_tr_b16 v[98:99], v30 offset:13312
    ds_read_b64_tr_b16 a[30:31], v11 offset:35328
    v_mfma_f32_32x32x16_bf16 v[224:239], v[72:75], v[84:87], v[224:239]
    v_mfma_f32_32x32x16_bf16 v[176:191], v[76:79], v[80:83], v[176:191]
    ds_read_b64_tr_b16 v[100:101], v31 offset:12288
    ds_read_b64_tr_b16 v[102:103], v31 offset:13312
    buffer_load_dwordx4 v63, s[16:19], s80 offen offset:3072 lds
    s_add_u32 s80, s80, 32768
    v_mfma_f32_32x32x16_bf16 v[240:255], v[76:79], v[84:87], v[240:255]
    s_waitcnt lgkmcnt(5)
    v_mfma_f32_32x32x16_bf16 v[128:143], v[88:91], v[104:107], v[128:143]
    v_mfma_f32_32x32x16_bf16 v[192:207], v[88:91], v[108:111], v[192:207]
    s_waitcnt lgkmcnt(0)
    s_waitcnt vmcnt(12)
    s_waitcnt vmcnt(9)
    s_barrier
    ds_read_b128 v[80:83], v24 offset:16384
    ds_read_b64_tr_b16 v[64:65], v28 offset:32768
    v_mfma_f32_32x32x16_bf16 v[144:159], v[92:95], v[104:107], v[144:159]
    ds_read_b64_tr_b16 v[66:67], v28 offset:33792
    ds_read_b128 v[84:87], v24 offset:20480
    s_add_u32 m0, s81, 32768
    s_nop 0
    buffer_load_dwordx4 v60, s[16:19], s80 offen lds
    v_mfma_f32_32x32x16_bf16 v[208:223], v[92:95], v[108:111], v[208:223]
    ds_read_b64_tr_b16 v[68:69], v29 offset:32768
    ds_read_b64_tr_b16 v[70:71], v29 offset:33792
    v_mfma_f32_32x32x16_bf16 v[160:175], v[96:99], v[104:107], v[160:175]
    ds_read_b64_tr_b16 v[72:73], v30 offset:32768
    ds_read_b64_tr_b16 v[74:75], v30 offset:33792
    buffer_load_dwordx4 v61, s[16:19], s80 offen offset:1024 lds
    v_mfma_f32_32x32x16_bf16 v[224:239], v[96:99], v[108:111], v[224:239]
    ds_read_b64_tr_b16 v[76:77], v31 offset:32768
    ds_read_b64_tr_b16 v[78:79], v31 offset:33792
    ds_read_b128 a[176:179], v37 offset:0
    v_mfma_f32_32x32x16_bf16 v[176:191], v[100:103], v[104:107], v[176:191]
    ds_read_b128 a[180:183], v37 offset:512
    v_mfma_f32_32x32x16_bf16 v[240:255], v[100:103], v[108:111], v[240:255]
    buffer_load_dwordx4 v62, s[16:19], s80 offen offset:2048 lds
    s_waitcnt lgkmcnt(6)
    v_mfma_f32_32x32x16_bf16 v[128:143], v[64:67], v[80:83], v[128:143]
    ds_read_b128 v[104:107], v25 offset:16384
    ds_read_b64_tr_b16 v[88:89], v28 offset:36864
    ds_read_b128 a[184:187], v37 offset:1024
    v_mfma_f32_32x32x16_bf16 v[192:207], v[64:67], v[84:87], v[192:207]
    ds_read_b64_tr_b16 v[90:91], v28 offset:37888
    ds_read_b128 v[108:111], v25 offset:20480
    v_mfma_f32_32x32x16_bf16 v[144:159], v[68:71], v[80:83], v[144:159]
    buffer_load_dwordx4 v63, s[16:19], s80 offen offset:3072 lds
    s_add_u32 s80, s80, 32768
    ds_read_b128 a[188:191], v37 offset:1536
    v_mfma_f32_32x32x16_bf16 v[208:223], v[68:71], v[84:87], v[208:223]
    ds_read_b64_tr_b16 v[92:93], v29 offset:36864
    ds_read_b64_tr_b16 v[94:95], v29 offset:37888
    s_waitcnt lgkmcnt(10)
    v_mfma_f32_32x32x16_bf16 v[160:175], v[72:75], v[80:83], v[160:175]
    ds_read_b64_tr_b16 v[96:97], v30 offset:36864
    ds_read_b64_tr_b16 v[98:99], v30 offset:37888
    ds_read_b128 a[192:195], v37 offset:2048
    v_mfma_f32_32x32x16_bf16 v[224:239], v[72:75], v[84:87], v[224:239]
    s_add_u32 m0, s81, 49152
    s_nop 0
    buffer_load_dwordx4 v60, s[16:19], s80 offen lds
    s_waitcnt vmcnt(9)
    ds_read_b64_tr_b16 a[32:33], v10 offset:0
    v_mfma_f32_32x32x16_bf16 v[176:191], v[76:79], v[80:83], v[176:191]
    ds_read_b64_tr_b16 v[100:101], v31 offset:36864
    ds_read_b64_tr_b16 v[102:103], v31 offset:37888
    ds_read_b64_tr_b16 a[34:35], v10 offset:512
    v_mfma_f32_32x32x16_bf16 v[240:255], v[76:79], v[84:87], v[240:255]
    ds_read_b64_tr_b16 a[36:37], v11 offset:0
    ds_read_b64_tr_b16 a[38:39], v11 offset:512
    ds_read_b64_tr_b16 a[40:41], v10 offset:2048
    s_waitcnt lgkmcnt(10)
    v_mfma_f32_32x32x16_bf16 v[128:143], v[88:91], v[104:107], v[128:143]
    ds_read_b128 v[80:83], v26 offset:16384
    ds_read_b64_tr_b16 v[64:65], v28 offset:40960
    buffer_load_dwordx4 v61, s[16:19], s80 offen offset:1024 lds
    v_mfma_f32_32x32x16_bf16 v[192:207], v[88:91], v[108:111], v[192:207]
    ds_read_b64_tr_b16 v[66:67], v28 offset:41984
    ds_read_b128 v[84:87], v26 offset:20480
    ds_read_b64_tr_b16 a[42:43], v10 offset:2560
    v_mfma_f32_32x32x16_bf16 v[144:159], v[92:95], v[104:107], v[144:159]
    ds_read_b64_tr_b16 a[44:45], v11 offset:2048
    ds_read_b64_tr_b16 a[46:47], v11 offset:2560
    ds_read_b128 a[196:199], v37 offset:2560
    v_mfma_f32_32x32x16_bf16 v[208:223], v[92:95], v[108:111], v[208:223]
    ds_read_b64_tr_b16 v[68:69], v29 offset:40960
    ds_read_b64_tr_b16 v[70:71], v29 offset:41984
    buffer_load_dwordx4 v62, s[16:19], s80 offen offset:2048 lds
    s_waitcnt lgkmcnt(14)
    v_mfma_f32_32x32x16_bf16 v[160:175], v[96:99], v[104:107], v[160:175]
    ds_read_b64_tr_b16 v[72:73], v30 offset:40960
    ds_read_b64_tr_b16 v[74:75], v30 offset:41984
    ds_read_b128 a[200:203], v37 offset:3072
    v_mfma_f32_32x32x16_bf16 v[224:239], v[96:99], v[108:111], v[224:239]
    ds_read_b128 a[204:207], v37 offset:3584
    ds_read_b128 a[208:211], v37 offset:4096
    v_mfma_f32_32x32x16_bf16 v[176:191], v[100:103], v[104:107], v[176:191]
    ds_read_b64_tr_b16 v[76:77], v31 offset:40960
    ds_read_b64_tr_b16 v[78:79], v31 offset:41984
    buffer_load_dwordx4 v63, s[16:19], s80 offen offset:3072 lds
    s_add_u32 s80, s80, 32768
    v_mfma_f32_32x32x16_bf16 v[240:255], v[100:103], v[108:111], v[240:255]
    ds_read_b128 a[212:215], v37 offset:4608
    s_waitcnt lgkmcnt(8)
    v_mfma_f32_32x32x16_bf16 v[128:143], v[64:67], v[80:83], v[128:143]
    ds_read_b128 v[104:107], v27 offset:16384
    ds_read_b64_tr_b16 v[88:89], v28 offset:45056
    ds_read_b128 a[216:219], v37 offset:5120
    v_mfma_f32_32x32x16_bf16 v[192:207], v[64:67], v[84:87], v[192:207]
    ds_read_b64_tr_b16 v[90:91], v28 offset:46080
    ds_read_b128 v[108:111], v27 offset:20480
    s_waitcnt vmcnt(8)
    ds_read_b64_tr_b16 a[48:49], v10 offset:16384
    v_mfma_f32_32x32x16_bf16 v[144:159], v[68:71], v[80:83], v[144:159]
    s_add_u32 m0, s81, 65536
    s_nop 0
    buffer_load_dwordx4 v60, s[16:19], s80 offen lds
    ds_read_b64_tr_b16 a[50:51], v10 offset:16896
    v_mfma_f32_32x32x16_bf16 v[208:223], v[68:71], v[84:87], v[208:223]
    ds_read_b64_tr_b16 v[92:93], v29 offset:45056
    ds_read_b64_tr_b16 v[94:95], v29 offset:46080
    ds_read_b64_tr_b16 a[52:53], v11 offset:16384
    s_waitcnt lgkmcnt(11)
    v_mfma_f32_32x32x16_bf16 v[160:175], v[72:75], v[80:83], v[160:175]
    ds_read_b64_tr_b16 v[96:97], v30 offset:45056
    ds_read_b64_tr_b16 v[98:99], v30 offset:46080
    buffer_load_dwordx4 v61, s[16:19], s80 offen offset:1024 lds
    v_mfma_f32_32x32x16_bf16 v[224:239], v[72:75], v[84:87], v[224:239]
    ds_read_b64_tr_b16 a[54:55], v11 offset:16896
    ds_read_b64_tr_b16 a[56:57], v10 offset:18432
    ds_read_b64_tr_b16 a[58:59], v10 offset:18944
    v_mfma_f32_32x32x16_bf16 v[176:191], v[76:79], v[80:83], v[176:191]
    ds_read_b64_tr_b16 v[100:101], v31 offset:45056
    ds_read_b64_tr_b16 v[102:103], v31 offset:46080
    ds_read_b64_tr_b16 a[60:61], v11 offset:18432
    ds_read_b64_tr_b16 a[62:63], v11 offset:18944
    v_mfma_f32_32x32x16_bf16 v[240:255], v[76:79], v[84:87], v[240:255]
    buffer_load_dwordx4 v62, s[16:19], s80 offen offset:2048 lds
    ds_read_b128 a[220:223], v37 offset:5632
    ds_read_b128 a[224:227], v37 offset:6144
    s_waitcnt lgkmcnt(12)
    v_mfma_f32_32x32x16_bf16 v[128:143], v[88:91], v[104:107], v[128:143]
    ds_read_b128 a[228:231], v37 offset:6656
    v_mfma_f32_32x32x16_bf16 v[192:207], v[88:91], v[108:111], v[192:207]
    ds_read_b128 a[232:235], v37 offset:7168
    v_mfma_f32_32x32x16_bf16 v[144:159], v[92:95], v[104:107], v[144:159]
    buffer_load_dwordx4 v63, s[16:19], s80 offen offset:3072 lds
    s_add_u32 s80, s80, 32768
    s_sub_u32 s80, s80, s46
    v_mfma_f32_32x32x16_bf16 v[208:223], v[92:95], v[108:111], v[208:223]
    ds_read_b128 a[236:239], v37 offset:7680
    s_waitcnt lgkmcnt(7)
    v_mfma_f32_32x32x16_bf16 v[160:175], v[96:99], v[104:107], v[160:175]
    v_mfma_f32_32x32x16_bf16 v[224:239], v[96:99], v[108:111], v[224:239]
    v_mfma_f32_32x32x16_bf16 v[176:191], v[100:103], v[104:107], v[176:191]
    v_mfma_f32_32x32x16_bf16 v[240:255], v[100:103], v[108:111], v[240:255]
    s_waitcnt lgkmcnt(0)
    s_barrier
    .p2align 3
    v_pk_mul_f32 v[64:65], v[128:129], s[48:49]
    v_pk_mul_f32 v[66:67], v[130:131], s[48:49]
    v_pk_mul_f32 v[68:69], v[136:137], s[48:49]
    v_pk_mul_f32 v[70:71], v[138:139], s[48:49]
    v_exp_f32 v64, v64
    v_exp_f32 v65, v65
    v_exp_f32 v66, v66
    v_exp_f32 v67, v67
    v_exp_f32 v68, v68
    v_exp_f32 v69, v69
    v_exp_f32 v70, v70
    v_exp_f32 v71, v71
    v_pk_mul_f32 v[128:129], v[128:129], v[132:133]
    v_pk_mul_f32 v[130:131], v[130:131], v[134:135]
    v_pk_mul_f32 v[136:137], v[136:137], v[140:141]
    v_pk_mul_f32 v[138:139], v[138:139], v[142:143]
    v_pk_add_f32 v[64:65], v[64:65], 1.0 op_sel_hi:[1,0]
    v_pk_add_f32 v[66:67], v[66:67], 1.0 op_sel_hi:[1,0]
    v_pk_add_f32 v[68:69], v[68:69], 1.0 op_sel_hi:[1,0]
    v_pk_add_f32 v[70:71], v[70:71], 1.0 op_sel_hi:[1,0]
    v_rcp_f32 v64, v64
    v_rcp_f32 v65, v65
    v_rcp_f32 v66, v66
    v_rcp_f32 v67, v67
    v_rcp_f32 v68, v68
    v_rcp_f32 v69, v69
    v_rcp_f32 v70, v70
    v_rcp_f32 v71, v71
    v_pk_mul_f32 v[128:129], v[128:129], v[64:65]
    v_pk_mul_f32 v[130:131], v[130:131], v[66:67]
    v_pk_mul_f32 v[136:137], v[136:137], v[68:69]
    v_pk_mul_f32 v[138:139], v[138:139], v[70:71]
    v_cvt_pk_bf16_f32 v132, v128, v129
    v_cvt_pk_bf16_f32 v133, v130, v131
    v_cvt_pk_bf16_f32 v134, v136, v137
    v_cvt_pk_bf16_f32 v135, v138, v139
    buffer_store_dwordx4 v[132:135], v38, s[12:15], s45 offen offset:0 sc1
    .p2align 3
    v_pk_mul_f32 v[72:73], v[144:145], s[48:49]
    v_pk_mul_f32 v[74:75], v[146:147], s[48:49]
    v_pk_mul_f32 v[76:77], v[152:153], s[48:49]
    v_pk_mul_f32 v[78:79], v[154:155], s[48:49]
    v_exp_f32 v72, v72
    v_exp_f32 v73, v73
    v_exp_f32 v74, v74
    v_exp_f32 v75, v75
    v_exp_f32 v76, v76
    v_exp_f32 v77, v77
    v_exp_f32 v78, v78
    v_exp_f32 v79, v79
    v_pk_mul_f32 v[144:145], v[144:145], v[148:149]
    v_pk_mul_f32 v[146:147], v[146:147], v[150:151]
    v_pk_mul_f32 v[152:153], v[152:153], v[156:157]
    v_pk_mul_f32 v[154:155], v[154:155], v[158:159]
    v_pk_add_f32 v[72:73], v[72:73], 1.0 op_sel_hi:[1,0]
    v_pk_add_f32 v[74:75], v[74:75], 1.0 op_sel_hi:[1,0]
    v_pk_add_f32 v[76:77], v[76:77], 1.0 op_sel_hi:[1,0]
    v_pk_add_f32 v[78:79], v[78:79], 1.0 op_sel_hi:[1,0]
    v_rcp_f32 v72, v72
    v_rcp_f32 v73, v73
    v_rcp_f32 v74, v74
    v_rcp_f32 v75, v75
    v_rcp_f32 v76, v76
    v_rcp_f32 v77, v77
    v_rcp_f32 v78, v78
    v_rcp_f32 v79, v79
    v_pk_mul_f32 v[144:145], v[144:145], v[72:73]
    v_pk_mul_f32 v[146:147], v[146:147], v[74:75]
    v_pk_mul_f32 v[152:153], v[152:153], v[76:77]
    v_pk_mul_f32 v[154:155], v[154:155], v[78:79]
    v_cvt_pk_bf16_f32 v148, v144, v145
    v_cvt_pk_bf16_f32 v149, v146, v147
    v_cvt_pk_bf16_f32 v150, v152, v153
    v_cvt_pk_bf16_f32 v151, v154, v155
    buffer_store_dwordx4 v[148:151], v38, s[12:15], s45 offen offset:1024 sc1
    .p2align 3
    v_pk_mul_f32 v[64:65], v[160:161], s[48:49]
    v_pk_mul_f32 v[66:67], v[162:163], s[48:49]
    v_pk_mul_f32 v[68:69], v[168:169], s[48:49]
    v_pk_mul_f32 v[70:71], v[170:171], s[48:49]
    v_exp_f32 v64, v64
    v_exp_f32 v65, v65
    v_exp_f32 v66, v66
    v_exp_f32 v67, v67
    v_exp_f32 v68, v68
    v_exp_f32 v69, v69
    v_exp_f32 v70, v70
    v_exp_f32 v71, v71
    v_pk_mul_f32 v[160:161], v[160:161], v[164:165]
    v_pk_mul_f32 v[162:163], v[162:163], v[166:167]
    v_pk_mul_f32 v[168:169], v[168:169], v[172:173]
    v_pk_mul_f32 v[170:171], v[170:171], v[174:175]
    v_pk_add_f32 v[64:65], v[64:65], 1.0 op_sel_hi:[1,0]
    v_pk_add_f32 v[66:67], v[66:67], 1.0 op_sel_hi:[1,0]
    v_pk_add_f32 v[68:69], v[68:69], 1.0 op_sel_hi:[1,0]
    v_pk_add_f32 v[70:71], v[70:71], 1.0 op_sel_hi:[1,0]
    v_rcp_f32 v64, v64
    v_rcp_f32 v65, v65
    v_rcp_f32 v66, v66
    v_rcp_f32 v67, v67
    v_rcp_f32 v68, v68
    v_rcp_f32 v69, v69
    v_rcp_f32 v70, v70
    v_rcp_f32 v71, v71
    v_pk_mul_f32 v[160:161], v[160:161], v[64:65]
    v_pk_mul_f32 v[162:163], v[162:163], v[66:67]
    v_pk_mul_f32 v[168:169], v[168:169], v[68:69]
    v_pk_mul_f32 v[170:171], v[170:171], v[70:71]
    v_cvt_pk_bf16_f32 v164, v160, v161
    v_cvt_pk_bf16_f32 v165, v162, v163
    v_cvt_pk_bf16_f32 v166, v168, v169
    v_cvt_pk_bf16_f32 v167, v170, v171
    buffer_store_dwordx4 v[164:167], v38, s[12:15], s45 offen offset:2048 sc1
    .p2align 3
    v_pk_mul_f32 v[72:73], v[176:177], s[48:49]
    v_pk_mul_f32 v[74:75], v[178:179], s[48:49]
    v_pk_mul_f32 v[76:77], v[184:185], s[48:49]
    v_pk_mul_f32 v[78:79], v[186:187], s[48:49]
    v_exp_f32 v72, v72
    v_exp_f32 v73, v73
    v_exp_f32 v74, v74
    v_exp_f32 v75, v75
    v_exp_f32 v76, v76
    v_exp_f32 v77, v77
    v_exp_f32 v78, v78
    v_exp_f32 v79, v79
    v_pk_mul_f32 v[176:177], v[176:177], v[180:181]
    v_pk_mul_f32 v[178:179], v[178:179], v[182:183]
    v_pk_mul_f32 v[184:185], v[184:185], v[188:189]
    v_pk_mul_f32 v[186:187], v[186:187], v[190:191]
    v_pk_add_f32 v[72:73], v[72:73], 1.0 op_sel_hi:[1,0]
    v_pk_add_f32 v[74:75], v[74:75], 1.0 op_sel_hi:[1,0]
    v_pk_add_f32 v[76:77], v[76:77], 1.0 op_sel_hi:[1,0]
    v_pk_add_f32 v[78:79], v[78:79], 1.0 op_sel_hi:[1,0]
    v_rcp_f32 v72, v72
    v_rcp_f32 v73, v73
    v_rcp_f32 v74, v74
    v_rcp_f32 v75, v75
    v_rcp_f32 v76, v76
    v_rcp_f32 v77, v77
    v_rcp_f32 v78, v78
    v_rcp_f32 v79, v79
    v_pk_mul_f32 v[176:177], v[176:177], v[72:73]
    v_pk_mul_f32 v[178:179], v[178:179], v[74:75]
    v_pk_mul_f32 v[184:185], v[184:185], v[76:77]
    v_pk_mul_f32 v[186:187], v[186:187], v[78:79]
    v_cvt_pk_bf16_f32 v180, v176, v177
    v_cvt_pk_bf16_f32 v181, v178, v179
    v_cvt_pk_bf16_f32 v182, v184, v185
    v_cvt_pk_bf16_f32 v183, v186, v187
    buffer_store_dwordx4 v[180:183], v38, s[12:15], s45 offen offset:3072 sc1
    .p2align 3
    v_pk_mul_f32 v[64:65], v[192:193], s[48:49]
    v_pk_mul_f32 v[66:67], v[194:195], s[48:49]
    v_pk_mul_f32 v[68:69], v[200:201], s[48:49]
    v_pk_mul_f32 v[70:71], v[202:203], s[48:49]
    v_exp_f32 v64, v64
    v_exp_f32 v65, v65
    v_exp_f32 v66, v66
    v_exp_f32 v67, v67
    v_exp_f32 v68, v68
    v_exp_f32 v69, v69
    v_exp_f32 v70, v70
    v_exp_f32 v71, v71
    v_pk_mul_f32 v[192:193], v[192:193], v[196:197]
    v_pk_mul_f32 v[194:195], v[194:195], v[198:199]
    v_pk_mul_f32 v[200:201], v[200:201], v[204:205]
    v_pk_mul_f32 v[202:203], v[202:203], v[206:207]
    v_pk_add_f32 v[64:65], v[64:65], 1.0 op_sel_hi:[1,0]
    v_pk_add_f32 v[66:67], v[66:67], 1.0 op_sel_hi:[1,0]
    v_pk_add_f32 v[68:69], v[68:69], 1.0 op_sel_hi:[1,0]
    v_pk_add_f32 v[70:71], v[70:71], 1.0 op_sel_hi:[1,0]
    v_rcp_f32 v64, v64
    v_rcp_f32 v65, v65
    v_rcp_f32 v66, v66
    v_rcp_f32 v67, v67
    v_rcp_f32 v68, v68
    v_rcp_f32 v69, v69
    v_rcp_f32 v70, v70
    v_rcp_f32 v71, v71
    v_pk_mul_f32 v[192:193], v[192:193], v[64:65]
    v_pk_mul_f32 v[194:195], v[194:195], v[66:67]
    v_pk_mul_f32 v[200:201], v[200:201], v[68:69]
    v_pk_mul_f32 v[202:203], v[202:203], v[70:71]
    v_cvt_pk_bf16_f32 v196, v192, v193
    v_cvt_pk_bf16_f32 v197, v194, v195
    v_cvt_pk_bf16_f32 v198, v200, v201
    v_cvt_pk_bf16_f32 v199, v202, v203
    buffer_store_dwordx4 v[196:199], v38, s[12:15], s50 offen offset:0 sc1
    .p2align 3
    v_pk_mul_f32 v[72:73], v[208:209], s[48:49]
    v_pk_mul_f32 v[74:75], v[210:211], s[48:49]
    v_pk_mul_f32 v[76:77], v[216:217], s[48:49]
    v_pk_mul_f32 v[78:79], v[218:219], s[48:49]
    v_exp_f32 v72, v72
    v_exp_f32 v73, v73
    v_exp_f32 v74, v74
    v_exp_f32 v75, v75
    v_exp_f32 v76, v76
    v_exp_f32 v77, v77
    v_exp_f32 v78, v78
    v_exp_f32 v79, v79
    v_pk_mul_f32 v[208:209], v[208:209], v[212:213]
    v_pk_mul_f32 v[210:211], v[210:211], v[214:215]
    v_pk_mul_f32 v[216:217], v[216:217], v[220:221]
    v_pk_mul_f32 v[218:219], v[218:219], v[222:223]
    v_pk_add_f32 v[72:73], v[72:73], 1.0 op_sel_hi:[1,0]
    v_pk_add_f32 v[74:75], v[74:75], 1.0 op_sel_hi:[1,0]
    v_pk_add_f32 v[76:77], v[76:77], 1.0 op_sel_hi:[1,0]
    v_pk_add_f32 v[78:79], v[78:79], 1.0 op_sel_hi:[1,0]
    v_rcp_f32 v72, v72
    v_rcp_f32 v73, v73
    v_rcp_f32 v74, v74
    v_rcp_f32 v75, v75
    v_rcp_f32 v76, v76
    v_rcp_f32 v77, v77
    v_rcp_f32 v78, v78
    v_rcp_f32 v79, v79
    v_pk_mul_f32 v[208:209], v[208:209], v[72:73]
    v_pk_mul_f32 v[210:211], v[210:211], v[74:75]
    v_pk_mul_f32 v[216:217], v[216:217], v[76:77]
    v_pk_mul_f32 v[218:219], v[218:219], v[78:79]
    v_cvt_pk_bf16_f32 v212, v208, v209
    v_cvt_pk_bf16_f32 v213, v210, v211
    v_cvt_pk_bf16_f32 v214, v216, v217
    v_cvt_pk_bf16_f32 v215, v218, v219
    buffer_store_dwordx4 v[212:215], v38, s[12:15], s50 offen offset:1024 sc1
    .p2align 3
    v_pk_mul_f32 v[64:65], v[224:225], s[48:49]
    v_pk_mul_f32 v[66:67], v[226:227], s[48:49]
    v_pk_mul_f32 v[68:69], v[232:233], s[48:49]
    v_pk_mul_f32 v[70:71], v[234:235], s[48:49]
    v_exp_f32 v64, v64
    v_exp_f32 v65, v65
    v_exp_f32 v66, v66
    v_exp_f32 v67, v67
    v_exp_f32 v68, v68
    v_exp_f32 v69, v69
    v_exp_f32 v70, v70
    v_exp_f32 v71, v71
    v_pk_mul_f32 v[224:225], v[224:225], v[228:229]
    v_pk_mul_f32 v[226:227], v[226:227], v[230:231]
    v_pk_mul_f32 v[232:233], v[232:233], v[236:237]
    v_pk_mul_f32 v[234:235], v[234:235], v[238:239]
    v_pk_add_f32 v[64:65], v[64:65], 1.0 op_sel_hi:[1,0]
    v_pk_add_f32 v[66:67], v[66:67], 1.0 op_sel_hi:[1,0]
    v_pk_add_f32 v[68:69], v[68:69], 1.0 op_sel_hi:[1,0]
    v_pk_add_f32 v[70:71], v[70:71], 1.0 op_sel_hi:[1,0]
    v_rcp_f32 v64, v64
    v_rcp_f32 v65, v65
    v_rcp_f32 v66, v66
    v_rcp_f32 v67, v67
    v_rcp_f32 v68, v68
    v_rcp_f32 v69, v69
    v_rcp_f32 v70, v70
    v_rcp_f32 v71, v71
    v_pk_mul_f32 v[224:225], v[224:225], v[64:65]
    v_pk_mul_f32 v[226:227], v[226:227], v[66:67]
    v_pk_mul_f32 v[232:233], v[232:233], v[68:69]
    v_pk_mul_f32 v[234:235], v[234:235], v[70:71]
    v_cvt_pk_bf16_f32 v228, v224, v225
    v_cvt_pk_bf16_f32 v229, v226, v227
    v_cvt_pk_bf16_f32 v230, v232, v233
    v_cvt_pk_bf16_f32 v231, v234, v235
    buffer_store_dwordx4 v[228:231], v38, s[12:15], s50 offen offset:2048 sc1
    .p2align 3
    v_pk_mul_f32 v[72:73], v[240:241], s[48:49]
    v_pk_mul_f32 v[74:75], v[242:243], s[48:49]
    v_pk_mul_f32 v[76:77], v[248:249], s[48:49]
    v_pk_mul_f32 v[78:79], v[250:251], s[48:49]
    v_exp_f32 v72, v72
    v_exp_f32 v73, v73
    v_exp_f32 v74, v74
    v_exp_f32 v75, v75
    v_exp_f32 v76, v76
    v_exp_f32 v77, v77
    v_exp_f32 v78, v78
    v_exp_f32 v79, v79
    v_pk_mul_f32 v[240:241], v[240:241], v[244:245]
    v_pk_mul_f32 v[242:243], v[242:243], v[246:247]
    v_pk_mul_f32 v[248:249], v[248:249], v[252:253]
    v_pk_mul_f32 v[250:251], v[250:251], v[254:255]
    v_pk_add_f32 v[72:73], v[72:73], 1.0 op_sel_hi:[1,0]
    v_pk_add_f32 v[74:75], v[74:75], 1.0 op_sel_hi:[1,0]
    v_pk_add_f32 v[76:77], v[76:77], 1.0 op_sel_hi:[1,0]
    v_pk_add_f32 v[78:79], v[78:79], 1.0 op_sel_hi:[1,0]
    v_rcp_f32 v72, v72
    v_rcp_f32 v73, v73
    v_rcp_f32 v74, v74
    v_rcp_f32 v75, v75
    v_rcp_f32 v76, v76
    v_rcp_f32 v77, v77
    v_rcp_f32 v78, v78
    v_rcp_f32 v79, v79
    v_pk_mul_f32 v[240:241], v[240:241], v[72:73]
    v_pk_mul_f32 v[242:243], v[242:243], v[74:75]
    v_pk_mul_f32 v[248:249], v[248:249], v[76:77]
    v_pk_mul_f32 v[250:251], v[250:251], v[78:79]
    v_cvt_pk_bf16_f32 v244, v240, v241
    v_cvt_pk_bf16_f32 v245, v242, v243
    v_cvt_pk_bf16_f32 v246, v248, v249
    v_cvt_pk_bf16_f32 v247, v250, v251
    buffer_store_dwordx4 v[244:247], v38, s[12:15], s50 offen offset:3072 sc1
L_cjoin:
    v_add_u32 v14, s53, v38
    v_mov_b32 v16, v58
    v_mov_b32 v17, v59
    v_mfma_f32_32x32x16_bf16 v[64:79], a[180:183], a[112:115], 0
    s_waitcnt vmcnt(16)
    ds_read_b64_tr_b16 a[64:65], v10 offset:32768
    ds_read_b64_tr_b16 a[66:67], v10 offset:33280
    v_lshlrev_b32 v18, 3, v1
    v_mfma_f32_32x32x16_bf16 v[64:79], a[176:179], a[116:119], v[64:79]
    ds_read_b64_tr_b16 a[68:69], v11 offset:32768
    ds_read_b64_tr_b16 a[70:71], v11 offset:33280
    s_add_u32 m0, s81, 81920
    s_nop 0
    buffer_load_dwordx4 v60, s[16:19], s80 offen lds
    v_mfma_f32_32x32x16_bf16 v[80:95], a[188:191], a[112:115], 0
    ds_read_b64_tr_b16 a[72:73], v10 offset:34816
    ds_read_b64_tr_b16 a[74:75], v10 offset:35328
    v_add_u32 v19, s54, v38
    v_mfma_f32_32x32x16_bf16 v[80:95], a[184:187], a[116:119], v[80:95]
    ds_read_b64_tr_b16 a[76:77], v11 offset:34816
    ds_read_b64_tr_b16 a[78:79], v11 offset:35328
    s_waitcnt vmcnt(13)
    ds_read_b64_tr_b16 a[80:81], v10 offset:49152
    v_mfma_f32_32x32x16_bf16 v[80:95], a[180:183], a[120:123], v[80:95]
    ds_read_b64_tr_b16 a[82:83], v10 offset:49664
    ds_read_b64_tr_b16 a[84:85], v11 offset:49152
    buffer_load_dwordx4 v61, s[16:19], s80 offen offset:1024 lds
    v_mov_b32 v116, v65
    v_mfma_f32_32x32x16_bf16 v[80:95], a[176:179], a[124:127], v[80:95]
    ds_read_b64_tr_b16 a[86:87], v11 offset:49664
    v_mov_b32 v120, v64
    v_mov_b32 v112, v66
    v_add_f32_dpp v113, v67, v70 wave_ror:1 row_mask:0xf bank_mask:0xf
    v_add_f32_dpp v114, v71, v74 wave_ror:1 row_mask:0xf bank_mask:0xf
    v_add_f32_dpp v115, v75, v78 wave_ror:1 row_mask:0xf bank_mask:0xf
    v_mfma_f32_32x32x16_bf16 v[96:111], a[196:199], a[112:115], 0
    ds_read_b64_tr_b16 a[88:89], v10 offset:51200
    buffer_load_dwordx4 v62, s[16:19], s80 offen offset:2048 lds
    v_add_f32_dpp v112, v67, v66 wave_shr:1 row_mask:0xf bank_mask:0xf
    v_add_f32_dpp v113, v71, v70 wave_shr:1 row_mask:0xf bank_mask:0xf
    v_add_f32_dpp v114, v75, v74 wave_shr:1 row_mask:0xf bank_mask:0xf
    v_mfma_f32_32x32x16_bf16 v[96:111], a[192:195], a[116:119], v[96:111]
    ds_read_b64_tr_b16 a[90:91], v10 offset:51712
    v_add_f32_dpp v115, v79, v78 wave_shr:1 row_mask:0xf bank_mask:0xf
    v_mov_b32 v47, v79
    v_add_f32_dpp v117, v112, v69 wave_ror:1 row_mask:0xf bank_mask:0xf
    v_add_f32_dpp v118, v113, v73 wave_ror:1 row_mask:0xf bank_mask:0xf
    v_add_f32_dpp v119, v114, v77 wave_ror:1 row_mask:0xf bank_mask:0xf
    v_mfma_f32_32x32x16_bf16 v[96:111], a[188:191], a[120:123], v[96:111]
    ds_read_b64_tr_b16 a[92:93], v11 offset:51200
    buffer_load_dwordx4 v63, s[16:19], s80 offen offset:3072 lds
    s_add_u32 s80, s80, 32768
    v_add_f32_dpp v116, v112, v65 wave_shr:1 row_mask:0xf bank_mask:0xf
    v_add_f32_dpp v117, v113, v69 wave_shr:1 row_mask:0xf bank_mask:0xf
    v_mfma_f32_32x32x16_bf16 v[96:111], a[184:187], a[124:127], v[96:111]
    ds_read_b64_tr_b16 a[94:95], v11 offset:51712
    s_waitcnt vmcnt(12)
    ds_read_b64_tr_b16 a[96:97], v16 offset:0
    ds_read_b64_tr_b16 a[98:99], v16 offset:512
    v_mfma_f32_32x32x16_bf16 v[96:111], a[180:183], a[128:131], v[96:111]
    ds_read_b64_tr_b16 a[100:101], v17 offset:0
    s_add_u32 m0, s81, 98304
    s_nop 0
    buffer_load_dwordx4 v60, s[16:19], s80 offen lds
    v_add_f32_dpp v118, v114, v73 wave_shr:1 row_mask:0xf bank_mask:0xf
    v_add_f32_dpp v119, v115, v77 wave_shr:1 row_mask:0xf bank_mask:0xf
    v_add_f32_dpp v121, v116, v68 wave_ror:1 row_mask:0xf bank_mask:0xf
    v_add_f32_dpp v122, v117, v72 wave_ror:1 row_mask:0xf bank_mask:0xf
    v_add_f32_dpp v123, v118, v76 wave_ror:1 row_mask:0xf bank_mask:0xf
    v_add_f32_dpp v120, v116, v64 wave_shr:1 row_mask:0xf bank_mask:0xf
    v_add_f32_dpp v121, v117, v68 wave_shr:1 row_mask:0xf bank_mask:0xf
    v_add_f32_dpp v122, v118, v72 wave_shr:1 row_mask:0xf bank_mask:0xf
    v_add_f32_dpp v123, v119, v76 wave_shr:1 row_mask:0xf bank_mask:0xf
    v_mfma_f32_32x32x16_bf16 v[96:111], a[176:179], a[132:135], v[96:111]
    ds_read_b64_tr_b16 a[102:103], v17 offset:512
    v_add_f32_dpp v116, v115, v81 wave_ror:1 row_mask:0xf bank_mask:0xf
    v_add_f32_dpp v124, v119, v80 wave_ror:1 row_mask:0xf bank_mask:0xf
    v_add_f32_dpp v112, v47, v82 wave_ror:1 row_mask:0xf bank_mask:0xf
    v_add_f32_dpp v113, v83, v86 wave_ror:1 row_mask:0xf bank_mask:0xf
    v_mfma_f32_32x32x16_bf16 v[64:79], a[204:207], a[112:115], 0
    ds_read_b64_tr_b16 a[104:105], v16 offset:2048
    buffer_load_dwordx4 v61, s[16:19], s80 offen offset:1024 lds
    v_add_f32_dpp v114, v87, v90 wave_ror:1 row_mask:0xf bank_mask:0xf
    v_add_f32_dpp v115, v91, v94 wave_ror:1 row_mask:0xf bank_mask:0xf
    v_add_f32_dpp v112, v83, v82 wave_shr:1 row_mask:0xf bank_mask:0xf
    v_mfma_f32_32x32x16_bf16 v[64:79], a[200:203], a[116:119], v[64:79]
    ds_read_b64_tr_b16 a[106:107], v16 offset:2560
    v_add_f32_dpp v113, v87, v86 wave_shr:1 row_mask:0xf bank_mask:0xf
    v_add_f32_dpp v114, v91, v90 wave_shr:1 row_mask:0xf bank_mask:0xf
    v_add_f32_dpp v115, v95, v94 wave_shr:1 row_mask:0xf bank_mask:0xf
    v_mov_b32 v47, v95
    v_mfma_f32_32x32x16_bf16 v[64:79], a[196:199], a[120:123], v[64:79]
    ds_read_b64_tr_b16 a[108:109], v17 offset:2048
    buffer_load_dwordx4 v62, s[16:19], s80 offen offset:2048 lds
    v_add_f32_dpp v117, v112, v85 wave_ror:1 row_mask:0xf bank_mask:0xf
    v_add_f32_dpp v118, v113, v89 wave_ror:1 row_mask:0xf bank_mask:0xf
    v_add_f32_dpp v119, v114, v93 wave_ror:1 row_mask:0xf bank_mask:0xf
    v_mfma_f32_32x32x16_bf16 v[64:79], a[192:195], a[124:127], v[64:79]
    ds_read_b64_tr_b16 a[110:111], v17 offset:2560
    v_add_f32_dpp v116, v112, v81 wave_shr:1 row_mask:0xf bank_mask:0xf
    v_add_f32_dpp v117, v113, v85 wave_shr:1 row_mask:0xf bank_mask:0xf
    v_add_f32_dpp v118, v114, v89 wave_shr:1 row_mask:0xf bank_mask:0xf
    v_add_f32_dpp v119, v115, v93 wave_shr:1 row_mask:0xf bank_mask:0xf
    v_mfma_f32_32x32x16_bf16 v[64:79], a[188:191], a[128:131], v[64:79]
    buffer_load_dwordx4 v63, s[16:19], s80 offen offset:3072 lds
    s_add_u32 s80, s80, 32768
    v_add_f32_dpp v125, v116, v84 wave_ror:1 row_mask:0xf bank_mask:0xf
    v_add_f32_dpp v126, v117, v88 wave_ror:1 row_mask:0xf bank_mask:0xf
    v_add_f32_dpp v127, v118, v92 wave_ror:1 row_mask:0xf bank_mask:0xf
    v_add_f32_dpp v124, v116, v80 wave_shr:1 row_mask:0xf bank_mask:0xf
    v_mfma_f32_32x32x16_bf16 v[64:79], a[184:187], a[132:135], v[64:79]
    v_add_f32_dpp v125, v117, v84 wave_shr:1 row_mask:0xf bank_mask:0xf
    v_add_f32_dpp v126, v118, v88 wave_shr:1 row_mask:0xf bank_mask:0xf
    v_add_f32_dpp v127, v119, v92 wave_shr:1 row_mask:0xf bank_mask:0xf
    v_mfma_f32_32x32x16_bf16 v[64:79], a[180:183], a[136:139], v[64:79]
    s_add_u32 m0, s81, 0
    s_nop 0
    buffer_load_dwordx4 v60, s[16:19], s80 offen lds
    v_add_f32_dpp v116, v115, v97 wave_ror:1 row_mask:0xf bank_mask:0xf
    v_add_f32_dpp v20, v119, v96 wave_ror:1 row_mask:0xf bank_mask:0xf
    v_add_f32_dpp v112, v47, v98 wave_ror:1 row_mask:0xf bank_mask:0xf
    v_mfma_f32_32x32x16_bf16 v[64:79], a[176:179], a[140:143], v[64:79]
    v_add_f32_dpp v113, v99, v102 wave_ror:1 row_mask:0xf bank_mask:0xf
    v_add_f32_dpp v114, v103, v106 wave_ror:1 row_mask:0xf bank_mask:0xf
    v_add_f32_dpp v115, v107, v110 wave_ror:1 row_mask:0xf bank_mask:0xf
    v_add_f32_dpp v112, v99, v98 wave_shr:1 row_mask:0xf bank_mask:0xf
    v_mfma_f32_32x32x16_bf16 v[80:95], a[212:215], a[112:115], 0
    buffer_load_dwordx4 v61, s[16:19], s80 offen offset:1024 lds
    v_add_f32_dpp v113, v103, v102 wave_shr:1 row_mask:0xf bank_mask:0xf
    v_add_f32_dpp v114, v107, v106 wave_shr:1 row_mask:0xf bank_mask:0xf
    v_add_f32_dpp v115, v111, v110 wave_shr:1 row_mask:0xf bank_mask:0xf
    v_mfma_f32_32x32x16_bf16 v[80:95], a[208:211], a[116:119], v[80:95]
    v_mov_b32 v47, v111
    v_add_f32_dpp v117, v112, v101 wave_ror:1 row_mask:0xf bank_mask:0xf
    v_add_f32_dpp v118, v113, v105 wave_ror:1 row_mask:0xf bank_mask:0xf
    v_mfma_f32_32x32x16_bf16 v[80:95], a[204:207], a[120:123], v[80:95]
    s_waitcnt vmcnt(10)
    s_waitcnt lgkmcnt(0)
    s_mov_b32 s90, s35
    s_atomic_swap s90, s[64:65], s51
    buffer_load_dwordx4 v62, s[16:19], s80 offen offset:2048 lds
    v_add_f32_dpp v119, v114, v109 wave_ror:1 row_mask:0xf bank_mask:0xf
    v_mfma_f32_32x32x16_bf16 v[80:95], a[200:203], a[124:127], v[80:95]
    v_add_f32_dpp v116, v112, v97 wave_shr:1 row_mask:0xf bank_mask:0xf
    v_add_f32_dpp v117, v113, v101 wave_shr:1 row_mask:0xf bank_mask:0xf
    v_add_f32_dpp v118, v114, v105 wave_shr:1 row_mask:0xf bank_mask:0xf
    v_add_f32_dpp v119, v115, v109 wave_shr:1 row_mask:0xf bank_mask:0xf
    v_add_f32_dpp v21, v116, v100 wave_ror:1 row_mask:0xf bank_mask:0xf
    v_mfma_f32_32x32x16_bf16 v[80:95], a[196:199], a[128:131], v[80:95]
    buffer_load_dwordx4 v63, s[16:19], s80 offen offset:3072 lds
    s_add_u32 s80, s80, 32768
    v_add_f32_dpp v22, v117, v104 wave_ror:1 row_mask:0xf bank_mask:0xf
    v_add_f32_dpp v23, v118, v108 wave_ror:1 row_mask:0xf bank_mask:0xf
    v_add_f32_dpp v20, v116, v96 wave_shr:1 row_mask:0xf bank_mask:0xf
    v_mfma_f32_32x32x16_bf16 v[80:95], a[192:195], a[132:135], v[80:95]
    v_add_f32_dpp v21, v117, v100 wave_shr:1 row_mask:0xf bank_mask:0xf
    v_add_f32_dpp v22, v118, v104 wave_shr:1 row_mask:0xf bank_mask:0xf
    v_add_f32_dpp v23, v119, v108 wave_shr:1 row_mask:0xf bank_mask:0xf
    v_mfma_f32_32x32x16_bf16 v[80:95], a[188:191], a[136:139], v[80:95]
    s_add_u32 m0, s81, 16384
    s_nop 0
    buffer_load_dwordx4 v60, s[16:19], s80 offen lds
    v_add_f32_dpp v116, v115, v65 wave_ror:1 row_mask:0xf bank_mask:0xf
    v_add_f32_dpp v24, v119, v64 wave_ror:1 row_mask:0xf bank_mask:0xf
    v_add_f32_dpp v112, v47, v66 wave_ror:1 row_mask:0xf bank_mask:0xf
    v_mfma_f32_32x32x16_bf16 v[80:95], a[184:187], a[140:143], v[80:95]
    v_add_f32_dpp v113, v67, v70 wave_ror:1 row_mask:0xf bank_mask:0xf
    v_add_f32_dpp v114, v71, v74 wave_ror:1 row_mask:0xf bank_mask:0xf
    v_add_f32_dpp v115, v75, v78 wave_ror:1 row_mask:0xf bank_mask:0xf
    v_add_f32_dpp v112, v67, v66 wave_shr:1 row_mask:0xf bank_mask:0xf
    v_mfma_f32_32x32x16_bf16 v[80:95], a[180:183], a[144:147], v[80:95]
    buffer_load_dwordx4 v61, s[16:19], s80 offen offset:1024 lds
    v_add_f32_dpp v113, v71, v70 wave_shr:1 row_mask:0xf bank_mask:0xf
    v_add_f32_dpp v114, v75, v74 wave_shr:1 row_mask:0xf bank_mask:0xf
    v_add_f32_dpp v115, v79, v78 wave_shr:1 row_mask:0xf bank_mask:0xf
    v_mfma_f32_32x32x16_bf16 v[80:95], a[176:179], a[148:151], v[80:95]
    v_mov_b32 v47, v79
    v_add_f32_dpp v117, v112, v69 wave_ror:1 row_mask:0xf bank_mask:0xf
    v_add_f32_dpp v118, v113, v73 wave_ror:1 row_mask:0xf bank_mask:0xf
    v_mfma_f32_32x32x16_bf16 v[96:111], a[220:223], a[112:115], 0
    buffer_load_dwordx4 v62, s[16:19], s80 offen offset:2048 lds
    v_add_f32_dpp v119, v114, v77 wave_ror:1 row_mask:0xf bank_mask:0xf
    v_add_f32_dpp v116, v112, v65 wave_shr:1 row_mask:0xf bank_mask:0xf
    v_add_f32_dpp v117, v113, v69 wave_shr:1 row_mask:0xf bank_mask:0xf
    v_mfma_f32_32x32x16_bf16 v[96:111], a[216:219], a[116:119], v[96:111]
    v_add_f32_dpp v118, v114, v73 wave_shr:1 row_mask:0xf bank_mask:0xf
    v_add_f32_dpp v119, v115, v77 wave_shr:1 row_mask:0xf bank_mask:0xf
    v_add_f32_dpp v25, v116, v68 wave_ror:1 row_mask:0xf bank_mask:0xf
    v_mfma_f32_32x32x16_bf16 v[96:111], a[212:215], a[120:123], v[96:111]
    buffer_load_dwordx4 v63, s[16:19], s80 offen offset:3072 lds
    s_add_u32 s80, s80, 32768
    v_add_f32_dpp v26, v117, v72 wave_ror:1 row_mask:0xf bank_mask:0xf
    v_add_f32_dpp v27, v118, v76 wave_ror:1 row_mask:0xf bank_mask:0xf
    v_add_f32_dpp v24, v116, v64 wave_shr:1 row_mask:0xf bank_mask:0xf
    v_mfma_f32_32x32x16_bf16 v[96:111], a[208:211], a[124:127], v[96:111]
    v_add_f32_dpp v25, v117, v68 wave_shr:1 row_mask:0xf bank_mask:0xf
    v_add_f32_dpp v26, v118, v72 wave_shr:1 row_mask:0xf bank_mask:0xf
    v_add_f32_dpp v27, v119, v76 wave_shr:1 row_mask:0xf bank_mask:0xf
    v_mfma_f32_32x32x16_bf16 v[96:111], a[204:207], a[128:131], v[96:111]
    s_add_u32 m0, s81, 32768
    s_nop 0
    buffer_load_dwordx4 v60, s[16:19], s80 offen lds
    v_add_f32_dpp v116, v115, v81 wave_ror:1 row_mask:0xf bank_mask:0xf
    v_add_f32_dpp v28, v119, v80 wave_ror:1 row_mask:0xf bank_mask:0xf
    v_mfma_f32_32x32x16_bf16 v[96:111], a[200:203], a[132:135], v[96:111]
    v_add_f32_dpp v112, v47, v82 wave_ror:1 row_mask:0xf bank_mask:0xf
    v_add_f32_dpp v113, v83, v86 wave_ror:1 row_mask:0xf bank_mask:0xf
    v_add_f32_dpp v114, v87, v90 wave_ror:1 row_mask:0xf bank_mask:0xf
    v_mfma_f32_32x32x16_bf16 v[96:111], a[196:199], a[136:139], v[96:111]
    buffer_load_dwordx4 v61, s[16:19], s80 offen offset:1024 lds
    v_add_f32_dpp v115, v91, v94 wave_ror:1 row_mask:0xf bank_mask:0xf
    v_add_f32_dpp v112, v83, v82 wave_shr:1 row_mask:0xf bank_mask:0xf
    v_add_f32_dpp v113, v87, v86 wave_shr:1 row_mask:0xf bank_mask:0xf
    v_mfma_f32_32x32x16_bf16 v[96:111], a[192:195], a[140:143], v[96:111]
    v_add_f32_dpp v114, v91, v90 wave_shr:1 row_mask:0xf bank_mask:0xf
    v_add_f32_dpp v115, v95, v94 wave_shr:1 row_mask:0xf bank_mask:0xf
    v_mfma_f32_32x32x16_bf16 v[96:111], a[188:191], a[144:147], v[96:111]
    buffer_load_dwordx4 v62, s[16:19], s80 offen offset:2048 lds
    v_mov_b32 v47, v95
    v_add_f32_dpp v117, v112, v85 wave_ror:1 row_mask:0xf bank_mask:0xf
    v_add_f32_dpp v118, v113, v89 wave_ror:1 row_mask:0xf bank_mask:0xf
    v_mfma_f32_32x32x16_bf16 v[96:111], a[184:187], a[148:151], v[96:111]
    v_add_f32_dpp v119, v114, v93 wave_ror:1 row_mask:0xf bank_mask:0xf
    v_add_f32_dpp v116, v112, v81 wave_shr:1 row_mask:0xf bank_mask:0xf
    v_mfma_f32_32x32x16_bf16 v[96:111], a[180:183], a[152:155], v[96:111]
    s_load_dwordx8 s[4:11], s[64:65], s52 glc
    buffer_load_dwordx4 v63, s[16:19], s80 offen offset:3072 lds
    s_add_u32 s80, s80, 32768
    v_add_f32_dpp v117, v113, v85 wave_shr:1 row_mask:0xf bank_mask:0xf
    v_add_f32_dpp v118, v114, v89 wave_shr:1 row_mask:0xf bank_mask:0xf
    v_add_f32_dpp v119, v115, v93 wave_shr:1 row_mask:0xf bank_mask:0xf
    v_mfma_f32_32x32x16_bf16 v[96:111], a[176:179], a[156:159], v[96:111]
    v_add_f32_dpp v29, v116, v84 wave_ror:1 row_mask:0xf bank_mask:0xf
    v_add_f32_dpp v30, v117, v88 wave_ror:1 row_mask:0xf bank_mask:0xf
    v_mfma_f32_32x32x16_bf16 v[64:79], a[228:231], a[112:115], 0
    s_add_u32 m0, s81, 49152
    s_nop 0
    buffer_load_dwordx4 v60, s[16:19], s80 offen lds
    v_add_f32_dpp v31, v118, v92 wave_ror:1 row_mask:0xf bank_mask:0xf
    v_add_f32_dpp v28, v116, v80 wave_shr:1 row_mask:0xf bank_mask:0xf
    v_mfma_f32_32x32x16_bf16 v[64:79], a[224:227], a[116:119], v[64:79]
    v_add_f32_dpp v29, v117, v84 wave_shr:1 row_mask:0xf bank_mask:0xf
    v_add_f32_dpp v30, v118, v88 wave_shr:1 row_mask:0xf bank_mask:0xf
    v_add_f32_dpp v31, v119, v92 wave_shr:1 row_mask:0xf bank_mask:0xf
    v_mfma_f32_32x32x16_bf16 v[64:79], a[220:223], a[120:123], v[64:79]
    buffer_load_dwordx4 v61, s[16:19], s80 offen offset:1024 lds
    v_mfma_f32_32x32x16_bf16 v[64:79], a[216:219], a[124:127], v[64:79]
    v_add_f32_dpp v116, v115, v97 wave_ror:1 row_mask:0xf bank_mask:0xf
    v_add_f32_dpp v32, v119, v96 wave_ror:1 row_mask:0xf bank_mask:0xf
    v_add_f32_dpp v112, v47, v98 wave_ror:1 row_mask:0xf bank_mask:0xf
    v_mfma_f32_32x32x16_bf16 v[64:79], a[212:215], a[128:131], v[64:79]
    buffer_load_dwordx4 v62, s[16:19], s80 offen offset:2048 lds
    v_add_f32_dpp v113, v99, v102 wave_ror:1 row_mask:0xf bank_mask:0xf
    v_add_f32_dpp v114, v103, v106 wave_ror:1 row_mask:0xf bank_mask:0xf
    v_mfma_f32_32x32x16_bf16 v[64:79], a[208:211], a[132:135], v[64:79]
    v_add_f32_dpp v115, v107, v110 wave_ror:1 row_mask:0xf bank_mask:0xf
    v_add_f32_dpp v112, v99, v98 wave_shr:1 row_mask:0xf bank_mask:0xf
    v_mfma_f32_32x32x16_bf16 v[64:79], a[204:207], a[136:139], v[64:79]
    buffer_load_dwordx4 v63, s[16:19], s80 offen offset:3072 lds
    s_add_u32 s80, s80, 32768
    v_add_f32_dpp v113, v103, v102 wave_shr:1 row_mask:0xf bank_mask:0xf
    v_add_f32_dpp v114, v107, v106 wave_shr:1 row_mask:0xf bank_mask:0xf
    v_mfma_f32_32x32x16_bf16 v[64:79], a[200:203], a[140:143], v[64:79]
    v_add_f32_dpp v115, v111, v110 wave_shr:1 row_mask:0xf bank_mask:0xf
    v_mov_b32 v47, v111
    v_mfma_f32_32x32x16_bf16 v[64:79], a[196:199], a[144:147], v[64:79]
    s_add_u32 m0, s81, 65536
    s_nop 0
    buffer_load_dwordx4 v60, s[16:19], s80 offen lds
    v_add_f32_dpp v117, v112, v101 wave_ror:1 row_mask:0xf bank_mask:0xf
    v_add_f32_dpp v118, v113, v105 wave_ror:1 row_mask:0xf bank_mask:0xf
    v_mfma_f32_32x32x16_bf16 v[64:79], a[192:195], a[148:151], v[64:79]
    v_add_f32_dpp v119, v114, v109 wave_ror:1 row_mask:0xf bank_mask:0xf
    v_add_f32_dpp v116, v112, v97 wave_shr:1 row_mask:0xf bank_mask:0xf
    v_mfma_f32_32x32x16_bf16 v[64:79], a[188:191], a[152:155], v[64:79]
    buffer_load_dwordx4 v61, s[16:19], s80 offen offset:1024 lds
    v_add_f32_dpp v117, v113, v101 wave_shr:1 row_mask:0xf bank_mask:0xf
    v_add_f32_dpp v118, v114, v105 wave_shr:1 row_mask:0xf bank_mask:0xf
    v_mfma_f32_32x32x16_bf16 v[64:79], a[184:187], a[156:159], v[64:79]
    v_add_f32_dpp v119, v115, v109 wave_shr:1 row_mask:0xf bank_mask:0xf
    v_add_f32_dpp v33, v116, v100 wave_ror:1 row_mask:0xf bank_mask:0xf
    v_mfma_f32_32x32x16_bf16 v[64:79], a[180:183], a[160:163], v[64:79]
    buffer_load_dwordx4 v62, s[16:19], s80 offen offset:2048 lds
    v_add_f32_dpp v34, v117, v104 wave_ror:1 row_mask:0xf bank_mask:0xf
    v_add_f32_dpp v35, v118, v108 wave_ror:1 row_mask:0xf bank_mask:0xf
    v_mfma_f32_32x32x16_bf16 v[64:79], a[176:179], a[164:167], v[64:79]
    v_add_f32_dpp v32, v116, v96 wave_shr:1 row_mask:0xf bank_mask:0xf
    v_add_f32_dpp v33, v117, v100 wave_shr:1 row_mask:0xf bank_mask:0xf
    v_add_f32_dpp v34, v118, v104 wave_shr:1 row_mask:0xf bank_mask:0xf
    v_add_f32_dpp v35, v119, v108 wave_shr:1 row_mask:0xf bank_mask:0xf
    v_mfma_f32_32x32x16_bf16 v[80:95], a[236:239], a[112:115], 0
    buffer_load_dwordx4 v63, s[16:19], s80 offen offset:3072 lds
    s_add_u32 s80, s80, 32768
    s_waitcnt lgkmcnt(0)
    s_xor_b32 s4, s4, s35
    s_xor_b32 s5, s5, s35
    s_xor_b32 s6, s6, s35
    s_xor_b32 s7, s7, s35
    s_xor_b32 s8, s8, s35
    v_mfma_f32_32x32x16_bf16 v[80:95], a[232:235], a[116:119], v[80:95]
    s_xor_b32 s9, s9, s35
    s_xor_b32 s10, s10, s35
    s_or_b32 s4, s4, s5
    s_or_b32 s6, s6, s7
    s_or_b32 s8, s8, s9
    v_mfma_f32_32x32x16_bf16 v[80:95], a[228:231], a[120:123], v[80:95]
    s_or_b32 s4, s4, s6
    s_or_b32 s8, s8, s10
    s_or_b32 s4, s4, s8
    s_cbranch_scc1 L_slowf2
L_backf2:
    v_mfma_f32_32x32x16_bf16 v[80:95], a[224:227], a[124:127], v[80:95]
    buffer_load_dwordx4 v[128:131], v12, s[12:15], s88 offen offset:0 sc1
    v_add_f32_dpp v116, v115, v65 wave_ror:1 row_mask:0xf bank_mask:0xf
    v_add_f32_dpp v48, v119, v64 wave_ror:1 row_mask:0xf bank_mask:0xf
    v_add_f32_dpp v112, v47, v66 wave_ror:1 row_mask:0xf bank_mask:0xf
    v_mfma_f32_32x32x16_bf16 v[80:95], a[220:223], a[128:131], v[80:95]
    buffer_load_dwordx4 v[132:135], v13, s[12:15], s88 offen offset:0 sc1
    v_add_f32_dpp v113, v67, v70 wave_ror:1 row_mask:0xf bank_mask:0xf
    v_add_f32_dpp v114, v71, v74 wave_ror:1 row_mask:0xf bank_mask:0xf
    v_mfma_f32_32x32x16_bf16 v[80:95], a[216:219], a[132:135], v[80:95]
    buffer_load_dwordx4 v[136:139], v12, s[12:15], s88 offen offset:1024 sc1
    v_add_f32_dpp v115, v75, v78 wave_ror:1 row_mask:0xf bank_mask:0xf
    v_add_f32_dpp v112, v67, v66 wave_shr:1 row_mask:0xf bank_mask:0xf
    v_mfma_f32_32x32x16_bf16 v[80:95], a[212:215], a[136:139], v[80:95]
    buffer_load_dwordx4 v[140:143], v13, s[12:15], s88 offen offset:1024 sc1
    v_add_f32_dpp v113, v71, v70 wave_shr:1 row_mask:0xf bank_mask:0xf
    v_add_f32_dpp v114, v75, v74 wave_shr:1 row_mask:0xf bank_mask:0xf
    v_mfma_f32_32x32x16_bf16 v[80:95], a[208:211], a[140:143], v[80:95]
    v_add_f32_dpp v115, v79, v78 wave_shr:1 row_mask:0xf bank_mask:0xf
    v_mov_b32 v47, v79
    v_mfma_f32_32x32x16_bf16 v[80:95], a[204:207], a[144:147], v[80:95]
    buffer_load_dwordx4 v[144:147], v12, s[12:15], s88 offen offset:2048 sc1
    v_add_f32_dpp v117, v112, v69 wave_ror:1 row_mask:0xf bank_mask:0xf
    v_add_f32_dpp v118, v113, v73 wave_ror:1 row_mask:0xf bank_mask:0xf
    v_mfma_f32_32x32x16_bf16 v[80:95], a[200:203], a[148:151], v[80:95]
    buffer_load_dwordx4 v[148:151], v13, s[12:15], s88 offen offset:2048 sc1
    v_add_f32_dpp v119, v114, v77 wave_ror:1 row_mask:0xf bank_mask:0xf
    v_add_f32_dpp v116, v112, v65 wave_shr:1 row_mask:0xf bank_mask:0xf
    v_mfma_f32_32x32x16_bf16 v[80:95], a[196:199], a[152:155], v[80:95]
    buffer_load_dwordx4 v[152:155], v12, s[12:15], s88 offen offset:3072 sc1
    v_add_f32_dpp v117, v113, v69 wave_shr:1 row_mask:0xf bank_mask:0xf
    v_add_f32_dpp v118, v114, v73 wave_shr:1 row_mask:0xf bank_mask:0xf
    v_mfma_f32_32x32x16_bf16 v[80:95], a[192:195], a[156:159], v[80:95]
    v_add_f32_dpp v119, v115, v77 wave_shr:1 row_mask:0xf bank_mask:0xf
    v_add_f32_dpp v49, v116, v68 wave_ror:1 row_mask:0xf bank_mask:0xf
    v_mfma_f32_32x32x16_bf16 v[80:95], a[188:191], a[160:163], v[80:95]
    buffer_load_dwordx4 v[156:159], v13, s[12:15], s88 offen offset:3072 sc1
    v_add_f32_dpp v50, v117, v72 wave_ror:1 row_mask:0xf bank_mask:0xf
    v_add_f32_dpp v51, v118, v76 wave_ror:1 row_mask:0xf bank_mask:0xf
    v_mfma_f32_32x32x16_bf16 v[80:95], a[184:187], a[164:167], v[80:95]
    s_add_u32 s88, s88, 4096
    buffer_load_dwordx4 v[160:163], v12, s[12:15], s88 offen offset:0 sc1
    v_add_f32_dpp v48, v116, v64 wave_shr:1 row_mask:0xf bank_mask:0xf
    v_add_f32_dpp v49, v117, v68 wave_shr:1 row_mask:0xf bank_mask:0xf
    v_mfma_f32_32x32x16_bf16 v[80:95], a[180:183], a[168:171], v[80:95]
    buffer_load_dwordx4 v[164:167], v13, s[12:15], s88 offen offset:0 sc1
    v_add_f32_dpp v50, v118, v72 wave_shr:1 row_mask:0xf bank_mask:0xf
    v_add_f32_dpp v51, v119, v76 wave_shr:1 row_mask:0xf bank_mask:0xf
    v_mfma_f32_32x32x16_bf16 v[80:95], a[176:179], a[172:175], v[80:95]
    s_waitcnt vmcnt(9)
    v_mfma_f32_32x32x16_bf16 v[240:255], a[0:3], v[128:131], 0
    buffer_load_dwordx4 v[168:171], v12, s[12:15], s88 offen offset:1024 sc1
    v_mfma_f32_32x32x16_bf16 a[176:191], a[4:7], v[128:131], 0
    ds_write_b128 v14, v[120:123] offset:0
    s_waitcnt vmcnt(9)
    v_mfma_f32_32x32x16_bf16 a[192:207], a[0:3], v[132:135], 0
    buffer_load_dwordx4 v[172:175], v13, s[12:15], s88 offen offset:1024 sc1
    v_mfma_f32_32x32x16_bf16 a[208:223], a[4:7], v[132:135], 0
    ds_write_b128 v14, v[124:127] offset:1024
    s_waitcnt vmcnt(9)
    v_mfma_f32_32x32x16_bf16 v[240:255], a[8:11], v[136:139], v[240:255]
    buffer_load_dwordx4 v[176:179], v12, s[12:15], s88 offen offset:2048 sc1
    v_add_f32_dpp v116, v115, v81 wave_ror:1 row_mask:0xf bank_mask:0xf
    v_add_f32_dpp v52, v119, v80 wave_ror:1 row_mask:0xf bank_mask:0xf
    v_add_f32_dpp v112, v47, v82 wave_ror:1 row_mask:0xf bank_mask:0xf
    v_add_f32_dpp v113, v83, v86 wave_ror:1 row_mask:0xf bank_mask:0xf
    v_add_f32_dpp v114, v87, v90 wave_ror:1 row_mask:0xf bank_mask:0xf
    v_mfma_f32_32x32x16_bf16 a[176:191], a[12:15], v[136:139], a[176:191]
    ds_write_b128 v14, v[20:23] offset:2048
    s_waitcnt vmcnt(9)
    v_mfma_f32_32x32x16_bf16 a[192:207], a[8:11], v[140:143], a[192:207]
    buffer_load_dwordx4 v[180:183], v13, s[12:15], s88 offen offset:2048 sc1
    v_add_f32_dpp v115, v91, v94 wave_ror:1 row_mask:0xf bank_mask:0xf
    v_add_f32_dpp v112, v83, v82 wave_shr:1 row_mask:0xf bank_mask:0xf
    v_add_f32_dpp v113, v87, v86 wave_shr:1 row_mask:0xf bank_mask:0xf
    v_add_f32_dpp v114, v91, v90 wave_shr:1 row_mask:0xf bank_mask:0xf
    v_add_f32_dpp v115, v95, v94 wave_shr:1 row_mask:0xf bank_mask:0xf
    v_mfma_f32_32x32x16_bf16 a[208:223], a[12:15], v[140:143], a[208:223]
    ds_write_b128 v14, v[24:27] offset:3072
    s_waitcnt vmcnt(9)
    v_mfma_f32_32x32x16_bf16 v[240:255], a[16:19], v[144:147], v[240:255]
    buffer_load_dwordx4 v[184:187], v12, s[12:15], s88 offen offset:3072 sc1
    v_add_f32_dpp v117, v112, v85 wave_ror:1 row_mask:0xf bank_mask:0xf
    v_add_f32_dpp v118, v113, v89 wave_ror:1 row_mask:0xf bank_mask:0xf
    v_add_f32_dpp v119, v114, v93 wave_ror:1 row_mask:0xf bank_mask:0xf
    v_add_f32_dpp v116, v112, v81 wave_shr:1 row_mask:0xf bank_mask:0xf
    v_add_f32_dpp v117, v113, v85 wave_shr:1 row_mask:0xf bank_mask:0xf
    v_mfma_f32_32x32x16_bf16 a[176:191], a[20:23], v[144:147], a[176:191]
    ds_write_b128 v14, v[28:31] offset:4096
    s_waitcnt vmcnt(9)
    v_mfma_f32_32x32x16_bf16 a[192:207], a[16:19], v[148:151], a[192:207]
    buffer_load_dwordx4 v[188:191], v13, s[12:15], s88 offen offset:3072 sc1
    v_add_f32_dpp v118, v114, v89 wave_shr:1 row_mask:0xf bank_mask:0xf
    v_add_f32_dpp v119, v115, v93 wave_shr:1 row_mask:0xf bank_mask:0xf
    v_add_f32_dpp v53, v116, v84 wave_ror:1 row_mask:0xf bank_mask:0xf
    v_add_f32_dpp v54, v117, v88 wave_ror:1 row_mask:0xf bank_mask:0xf
    v_add_f32_dpp v55, v118, v92 wave_ror:1 row_mask:0xf bank_mask:0xf
    v_mfma_f32_32x32x16_bf16 a[208:223], a[20:23], v[148:151], a[208:223]
    ds_write_b128 v14, v[32:35] offset:5120
    s_waitcnt vmcnt(9)
    v_mfma_f32_32x32x16_bf16 v[240:255], a[24:27], v[152:155], v[240:255]
    s_add_u32 s88, s88, 4096
    buffer_load_dwordx4 v[192:195], v12, s[12:15], s88 offen offset:0 sc1
    v_add_f32_dpp v52, v116, v80 wave_shr:1 row_mask:0xf bank_mask:0xf
    v_add_f32_dpp v53, v117, v84 wave_shr:1 row_mask:0xf bank_mask:0xf
    v_add_f32_dpp v54, v118, v88 wave_shr:1 row_mask:0xf bank_mask:0xf
    v_add_f32_dpp v55, v119, v92 wave_shr:1 row_mask:0xf bank_mask:0xf
    v_mfma_f32_32x32x16_bf16 a[176:191], a[28:31], v[152:155], a[176:191]
    ds_write_b128 v14, v[48:51] offset:6144
    s_waitcnt vmcnt(9)
    v_mfma_f32_32x32x16_bf16 a[192:207], a[24:27], v[156:159], a[192:207]
    buffer_load_dwordx4 v[196:199], v13, s[12:15], s88 offen offset:0 sc1
    v_mfma_f32_32x32x16_bf16 a[208:223], a[28:31], v[156:159], a[208:223]
    ds_write_b128 v14, v[52:55] offset:7168
    s_waitcnt vmcnt(9)
    v_mfma_f32_32x32x16_bf16 v[240:255], a[32:35], v[160:163], v[240:255]
    buffer_load_dwordx4 v[200:203], v12, s[12:15], s88 offen offset:1024 sc1
    v_mfma_f32_32x32x16_bf16 a[176:191], a[36:39], v[160:163], a[176:191]
    s_waitcnt lgkmcnt(0)
    s_barrier
    ds_read_b128 v[64:67], v19 offset:0
    s_waitcnt vmcnt(9)
    v_mfma_f32_32x32x16_bf16 a[192:207], a[32:35], v[164:167], a[192:207]
    buffer_load_dwordx4 v[204:207], v13, s[12:15], s88 offen offset:1024 sc1
    ds_read_b128 v[68:71], v19 offset:8192
    ds_read_b128 v[72:75], v19 offset:16384
    v_mov_b32 v49, v42
    v_mfma_f32_32x32x16_bf16 a[208:223], a[36:39], v[164:167], a[208:223]
    ds_read_b128 v[76:79], v19 offset:24576
    ds_read_b128 v[80:83], v19 offset:4096
    ds_read_b128 v[84:87], v19 offset:12288
    v_mov_b32 v51, v42
    s_waitcnt vmcnt(9)
    v_mfma_f32_32x32x16_bf16 v[240:255], a[40:43], v[168:171], v[240:255]
    buffer_load_dwordx4 v[208:211], v12, s[12:15], s88 offen offset:2048 sc1
    ds_read_b128 v[88:91], v19 offset:20480
    ds_read_b128 v[92:95], v19 offset:28672
    v_mov_b32 v53, v42
    v_mfma_f32_32x32x16_bf16 a[176:191], a[44:47], v[168:171], a[176:191]
    v_mov_b32 v55, v42
    v_mov_b32 v57, v42
    v_mov_b32 v59, v42
    v_mov_b32 v61, v42
    v_mov_b32 v63, v42
    s_waitcnt vmcnt(9)
    v_mfma_f32_32x32x16_bf16 a[192:207], a[40:43], v[172:175], a[192:207]
    buffer_load_dwordx4 v[212:215], v13, s[12:15], s88 offen offset:2048 sc1
    v_mfma_f32_32x32x16_bf16 a[208:223], a[44:47], v[172:175], a[208:223]
    s_waitcnt lgkmcnt(6)
    v_add_f32 v64, v64, v68
    v_add_f32 v65, v65, v69
    v_add_f32 v66, v66, v70
    s_waitcnt vmcnt(9)
    v_mfma_f32_32x32x16_bf16 v[240:255], a[48:51], v[176:179], v[240:255]
    buffer_load_dwordx4 v[216:219], v12, s[12:15], s88 offen offset:3072 sc1
    v_add_f32 v67, v67, v71
    s_waitcnt lgkmcnt(4)
    v_add_f32 v72, v72, v76
    v_add_f32 v73, v73, v77
    v_mfma_f32_32x32x16_bf16 a[176:191], a[52:55], v[176:179], a[176:191]
    v_add_f32 v74, v74, v78
    v_add_f32 v75, v75, v79
    v_cvt_pk_bf16_f32 v48, v64, v72
    s_waitcnt vmcnt(9)
    v_mfma_f32_32x32x16_bf16 a[192:207], a[48:51], v[180:183], a[192:207]
    buffer_load_dwordx4 v[220:223], v13, s[12:15], s88 offen offset:3072 sc1
    v_cvt_pk_bf16_f32 v50, v65, v73
    v_cvt_pk_bf16_f32 v52, v66, v74
    v_cvt_pk_bf16_f32 v54, v67, v75
    v_mfma_f32_32x32x16_bf16 a[208:223], a[52:55], v[180:183], a[208:223]
    s_waitcnt lgkmcnt(2)
    v_add_f32 v80, v80, v84
    v_add_f32 v81, v81, v85
    v_add_f32 v82, v82, v86
    s_waitcnt vmcnt(9)
    v_mfma_f32_32x32x16_bf16 v[240:255], a[56:59], v[184:187], v[240:255]
    s_add_u32 s88, s88, 4096
    buffer_load_dwordx4 v[224:227], v12, s[12:15], s88 offen offset:0 sc1
    v_add_f32 v83, v83, v87
    s_waitcnt lgkmcnt(0)
    v_add_f32 v88, v88, v92
    v_add_f32 v89, v89, v93
    v_mfma_f32_32x32x16_bf16 a[176:191], a[60:63], v[184:187], a[176:191]
    v_add_f32 v90, v90, v94
    v_add_f32 v91, v91, v95
    v_cvt_pk_bf16_f32 v56, v80, v88
    s_waitcnt vmcnt(9)
    v_mfma_f32_32x32x16_bf16 a[192:207], a[56:59], v[188:191], a[192:207]
    buffer_load_dwordx4 v[228:231], v13, s[12:15], s88 offen offset:0 sc1
    v_cvt_pk_bf16_f32 v58, v81, v89
    v_cvt_pk_bf16_f32 v60, v82, v90
    v_cvt_pk_bf16_f32 v62, v83, v91
    v_mfma_f32_32x32x16_bf16 a[208:223], a[60:63], v[188:191], a[208:223]
    buffer_store_dwordx2 v[48:49], v18, s[12:15], s55 offen offset:0 sc1
    s_xor_b32 s69, s24, 0
    s_waitcnt vmcnt(10)
    v_mfma_f32_32x32x16_bf16 v[240:255], a[64:67], v[192:195], v[240:255]
    buffer_load_dwordx4 v[232:235], v12, s[12:15], s88 offen offset:1024 sc1
    ds_read_b64_tr_b16 a[112:113], v16 offset:16384
    s_mul_i32 s69, s69, 12288
    v_mfma_f32_32x32x16_bf16 a[176:191], a[68:71], v[192:195], a[176:191]
    buffer_store_dwordx2 v[50:51], v18, s[12:15], s55 offen offset:512 sc1
    ds_read_b64_tr_b16 a[114:115], v16 offset:16896
    s_add_u32 s69, s69, 114688
    s_waitcnt vmcnt(11)
    v_mfma_f32_32x32x16_bf16 a[192:207], a[64:67], v[196:199], a[192:207]
    buffer_load_dwordx4 v[236:239], v13, s[12:15], s88 offen offset:1024 sc1
    ds_read_b64_tr_b16 a[116:117], v17 offset:16384
    v_add_u32 v24, s69, v38
    v_mfma_f32_32x32x16_bf16 a[208:223], a[68:71], v[196:199], a[208:223]
    buffer_store_dwordx2 v[52:53], v18, s[12:15], s55 offen offset:1024 sc1
    ds_read_b64_tr_b16 a[118:119], v17 offset:16896
    s_xor_b32 s69, s24, 1
    s_waitcnt vmcnt(12)
    v_mfma_f32_32x32x16_bf16 v[240:255], a[72:75], v[200:203], v[240:255]
    s_mov_b32 s88, s89
    buffer_load_dwordx4 v[128:131], v13, s[12:15], s88 offen offset:0 sc1
    ds_read_b64_tr_b16 a[120:121], v16 offset:18432
    s_mul_i32 s69, s69, 12288
    v_mfma_f32_32x32x16_bf16 a[176:191], a[76:79], v[200:203], a[176:191]
    buffer_store_dwordx2 v[54:55], v18, s[12:15], s55 offen offset:1536 sc1
    ds_read_b64_tr_b16 a[122:123], v16 offset:18944
    s_add_u32 s69, s69, 114688
    s_waitcnt vmcnt(13)
    v_mfma_f32_32x32x16_bf16 a[192:207], a[72:75], v[204:207], a[192:207]
    buffer_load_dwordx4 v[132:135], v13, s[12:15], s88 offen offset:1024 sc1
    ds_read_b64_tr_b16 a[124:125], v17 offset:18432
    ds_read_b64_tr_b16 a[126:127], v17 offset:18944
    v_add_u32 v25, s69, v38
    v_mfma_f32_32x32x16_bf16 a[208:223], a[76:79], v[204:207], a[208:223]
    buffer_store_dwordx2 v[56:57], v18, s[12:15], s40 offen offset:0 sc1
    ds_read_b64_tr_b16 a[128:129], v16 offset:32768
    s_waitcnt vmcnt(14)
    v_mfma_f32_32x32x16_bf16 v[240:255], a[80:83], v[208:211], v[240:255]
    buffer_load_dwordx4 v[136:139], v13, s[12:15], s88 offen offset:2048 sc1
    ds_read_b64_tr_b16 a[130:131], v16 offset:33280
    ds_read_b64_tr_b16 a[132:133], v17 offset:32768
    s_xor_b32 s69, s24, 2
    v_mfma_f32_32x32x16_bf16 a[176:191], a[84:87], v[208:211], a[176:191]
    buffer_store_dwordx2 v[58:59], v18, s[12:15], s40 offen offset:512 sc1
    ds_read_b64_tr_b16 a[134:135], v17 offset:33280
    s_mul_i32 s69, s69, 12288
    s_waitcnt vmcnt(15)
    v_mfma_f32_32x32x16_bf16 a[192:207], a[80:83], v[212:215], a[192:207]
    buffer_load_dwordx4 v[140:143], v13, s[12:15], s88 offen offset:3072 sc1
    ds_read_b64_tr_b16 a[136:137], v16 offset:34816
    ds_read_b64_tr_b16 a[138:139], v16 offset:35328
    s_add_u32 s69, s69, 114688
    v_mfma_f32_32x32x16_bf16 a[208:223], a[84:87], v[212:215], a[208:223]
    buffer_store_dwordx2 v[60:61], v18, s[12:15], s40 offen offset:1024 sc1
    ds_read_b64_tr_b16 a[140:141], v17 offset:34816
    v_add_u32 v26, s69, v38
    s_waitcnt vmcnt(16)
    v_mfma_f32_32x32x16_bf16 v[240:255], a[88:91], v[216:219], v[240:255]
    s_add_u32 s88, s88, 4096
    buffer_load_dwordx4 v[144:147], v13, s[12:15], s88 offen offset:0 sc1
    ds_read_b64_tr_b16 a[142:143], v17 offset:35328
    s_xor_b32 s69, s24, 3
    v_mfma_f32_32x32x16_bf16 a[176:191], a[92:95], v[216:219], a[176:191]
    buffer_store_dwordx2 v[62:63], v18, s[12:15], s40 offen offset:1536 sc1
    s_mul_i32 s69, s69, 12288
    s_waitcnt vmcnt(17)
    v_mfma_f32_32x32x16_bf16 a[192:207], a[88:91], v[220:223], a[192:207]
    buffer_load_dwordx4 v[148:151], v13, s[12:15], s88 offen offset:1024 sc1
    ds_read_b64_tr_b16 a[144:145], v10 offset:0
    s_add_u32 s69, s69, 114688
    v_mfma_f32_32x32x16_bf16 a[208:223], a[92:95], v[220:223], a[208:223]
    s_barrier
    ds_read_b64_tr_b16 a[146:147], v10 offset:512
    ds_read_b64_tr_b16 a[148:149], v11 offset:0
    ds_read_b64_tr_b16 a[150:151], v11 offset:512
    v_add_u32 v27, s69, v38
    s_waitcnt vmcnt(17)
    v_mfma_f32_32x32x16_bf16 v[240:255], a[96:99], v[224:227], v[240:255]
    buffer_load_dwordx4 v[152:155], v13, s[12:15], s88 offen offset:2048 sc1
    ds_read_b64_tr_b16 a[152:153], v10 offset:2048
    ds_read_b64_tr_b16 a[154:155], v10 offset:2560
    v_mfma_f32_32x32x16_bf16 a[176:191], a[100:103], v[224:227], a[176:191]
    ds_read_b64_tr_b16 a[156:157], v11 offset:2048
    v_add_u32 v28, 16384, v3
    s_waitcnt vmcnt(17)
    v_mfma_f32_32x32x16_bf16 a[192:207], a[96:99], v[228:231], a[192:207]
    buffer_load_dwordx4 v[156:159], v13, s[12:15], s88 offen offset:3072 sc1
    ds_read_b64_tr_b16 a[158:159], v11 offset:2560
    v_add_u32 v29, 32768, v3
    v_mfma_f32_32x32x16_bf16 a[208:223], a[100:103], v[228:231], a[208:223]
    ds_read_b64_tr_b16 a[160:161], v10 offset:16384
    ds_read_b64_tr_b16 a[162:163], v10 offset:16896
    v_add_u32 v30, 49152, v3
    s_waitcnt vmcnt(16)
    v_mfma_f32_32x32x16_bf16 v[240:255], a[104:107], v[232:235], v[240:255]
    s_add_u32 s88, s88, 4096
    buffer_load_dwordx4 v[160:163], v13, s[12:15], s88 offen offset:0 sc1
    ds_read_b64_tr_b16 a[164:165], v11 offset:16384
    v_add_u32 v31, 65536, v3
    v_mfma_f32_32x32x16_bf16 a[176:191], a[108:111], v[232:235], a[176:191]
    ds_read_b64_tr_b16 a[166:167], v11 offset:16896
    ds_read_b64_tr_b16 a[168:169], v10 offset:18432
    v_add_u32 v32, 81920, v3
    s_waitcnt vmcnt(15)
    v_mfma_f32_32x32x16_bf16 a[192:207], a[104:107], v[236:239], a[192:207]
    buffer_load_dwordx4 v[164:167], v13, s[12:15], s88 offen offset:1024 sc1
    ds_read_b64_tr_b16 a[170:171], v10 offset:18944
    v_add_u32 v33, 98304, v3
    v_mfma_f32_32x32x16_bf16 a[208:223], a[108:111], v[236:239], a[208:223]
    ds_read_b64_tr_b16 a[172:173], v11 offset:18432
    v_add_u32 v34, 114688, v3
    s_waitcnt vmcnt(14) lgkmcnt(15)
    v_mfma_f32_32x32x16_bf16 a[192:207], a[112:115], v[128:131], a[192:207]
    buffer_load_dwordx4 v[168:171], v13, s[12:15], s88 offen offset:2048 sc1
    ds_read_b64_tr_b16 a[174:175], v11 offset:18944
    ds_read_b64_tr_b16 a[0:1], v10 offset:32768
    v_mfma_f32_32x32x16_bf16 a[208:223], a[116:119], v[128:131], a[208:223]
    ds_read_b64_tr_b16 a[2:3], v10 offset:33280
    s_waitcnt vmcnt(13)
    v_mfma_f32_32x32x16_bf16 a[192:207], a[120:123], v[132:135], a[192:207]
    buffer_load_dwordx4 v[172:175], v13, s[12:15], s88 offen offset:3072 sc1
    ds_read_b64_tr_b16 a[4:5], v11 offset:32768
    v_mfma_f32_32x32x16_bf16 a[208:223], a[124:127], v[132:135], a[208:223]
    ds_read_b64_tr_b16 a[6:7], v11 offset:33280
    ds_read_b64_tr_b16 a[8:9], v10 offset:34816
    s_waitcnt vmcnt(12)
    v_mfma_f32_32x32x16_bf16 a[192:207], a[128:131], v[136:139], a[192:207]
    s_add_u32 s88, s88, 4096
    buffer_load_dwordx4 v[176:179], v13, s[12:15], s88 offen offset:0 sc1
    ds_read_b64_tr_b16 a[10:11], v10 offset:35328
    v_mfma_f32_32x32x16_bf16 a[208:223], a[132:135], v[136:139], a[208:223]
    ds_read_b64_tr_b16 a[12:13], v11 offset:34816
    s_waitcnt vmcnt(11)
    v_mfma_f32_32x32x16_bf16 a[192:207], a[136:139], v[140:143], a[192:207]
    buffer_load_dwordx4 v[180:183], v13, s[12:15], s88 offen offset:1024 sc1
    ds_read_b64_tr_b16 a[14:15], v11 offset:35328
    ds_read_b64_tr_b16 a[16:17], v10 offset:49152
    v_mfma_f32_32x32x16_bf16 a[208:223], a[140:143], v[140:143], a[208:223]
    ds_read_b64_tr_b16 a[18:19], v10 offset:49664
    s_waitcnt vmcnt(10) lgkmcnt(15)
    v_mfma_f32_32x32x16_bf16 a[192:207], a[144:147], v[144:147], a[192:207]
    s_mov_b32 s88, s89
    buffer_load_dwordx4 v[184:187], v12, s[12:15], s88 offen offset:0 sc1
    ds_read_b64_tr_b16 a[20:21], v11 offset:49152
    v_mfma_f32_32x32x16_bf16 a[208:223], a[148:151], v[144:147], a[208:223]
    ds_read_b64_tr_b16 a[22:23], v11 offset:49664
    ds_read_b64_tr_b16 a[24:25], v10 offset:51200
    s_waitcnt vmcnt(9)
    v_mfma_f32_32x32x16_bf16 a[192:207], a[152:155], v[148:151], a[192:207]
    buffer_load_dwordx4 v[188:191], v12, s[12:15], s88 offen offset:1024 sc1
    ds_read_b64_tr_b16 a[26:27], v10 offset:51712
    v_mfma_f32_32x32x16_bf16 a[208:223], a[156:159], v[148:151], a[208:223]
    ds_read_b64_tr_b16 a[28:29], v11 offset:51200
    s_waitcnt vmcnt(9)
    v_mfma_f32_32x32x16_bf16 a[192:207], a[160:163], v[152:155], a[192:207]
    buffer_load_dwordx4 v[192:195], v12, s[12:15], s88 offen offset:2048 sc1
    ds_read_b64_tr_b16 a[30:31], v11 offset:51712
    ds_read_b64_tr_b16 a[32:33], v16 offset:0
    s_waitcnt lgkmcnt(15)
    v_mfma_f32_32x32x16_bf16 a[208:223], a[164:167], v[152:155], a[208:223]
    ds_read_b64_tr_b16 a[34:35], v16 offset:512
    s_waitcnt vmcnt(9)
    v_mfma_f32_32x32x16_bf16 a[192:207], a[168:171], v[156:159], a[192:207]
    buffer_load_dwordx4 v[196:199], v12, s[12:15], s88 offen offset:3072 sc1
    ds_read_b64_tr_b16 a[36:37], v17 offset:0
    v_mfma_f32_32x32x16_bf16 a[208:223], a[172:175], v[156:159], a[208:223]
    ds_read_b64_tr_b16 a[38:39], v17 offset:512
    ds_read_b64_tr_b16 a[40:41], v16 offset:2048
    s_waitcnt vmcnt(9)
    v_mfma_f32_32x32x16_bf16 a[192:207], a[0:3], v[160:163], a[192:207]
    s_add_u32 s88, s88, 4096
    buffer_load_dwordx4 v[200:203], v12, s[12:15], s88 offen offset:0 sc1
    ds_read_b64_tr_b16 a[42:43], v16 offset:2560
    s_waitcnt lgkmcnt(15)
    v_mfma_f32_32x32x16_bf16 a[208:223], a[4:7], v[160:163], a[208:223]
    ds_read_b64_tr_b16 a[44:45], v17 offset:2048
    s_waitcnt vmcnt(9)
    v_mfma_f32_32x32x16_bf16 a[192:207], a[8:11], v[164:167], a[192:207]
    buffer_load_dwordx4 v[204:207], v12, s[12:15], s88 offen offset:1024 sc1
    ds_read_b64_tr_b16 a[46:47], v17 offset:2560
    s_waitcnt lgkmcnt(15)
    v_mfma_f32_32x32x16_bf16 a[208:223], a[12:15], v[164:167], a[208:223]
    s_waitcnt vmcnt(9) lgkmcnt(14)
    v_mfma_f32_32x32x16_bf16 a[192:207], a[16:19], v[168:171], a[192:207]
    buffer_load_dwordx4 v[208:211], v12, s[12:15], s88 offen offset:2048 sc1
    s_waitcnt lgkmcnt(12)
    v_mfma_f32_32x32x16_bf16 a[208:223], a[20:23], v[168:171], a[208:223]
    s_waitcnt vmcnt(9) lgkmcnt(10)
    v_mfma_f32_32x32x16_bf16 a[192:207], a[24:27], v[172:175], a[192:207]
    buffer_load_dwordx4 v[212:215], v12, s[12:15], s88 offen offset:3072 sc1
    s_waitcnt lgkmcnt(8)
    v_mfma_f32_32x32x16_bf16 a[208:223], a[28:31], v[172:175], a[208:223]
    s_waitcnt vmcnt(9) lgkmcnt(6)
    v_mfma_f32_32x32x16_bf16 a[192:207], a[32:35], v[176:179], a[192:207]
    s_add_u32 s88, s88, 4096
    buffer_load_dwordx4 v[216:219], v12, s[12:15], s88 offen offset:0 sc1
    s_waitcnt lgkmcnt(4)
    v_mfma_f32_32x32x16_bf16 a[208:223], a[36:39], v[176:179], a[208:223]
    s_waitcnt vmcnt(9) lgkmcnt(2)
    v_mfma_f32_32x32x16_bf16 a[192:207], a[40:43], v[180:183], a[192:207]
    buffer_load_dwordx4 v[220:223], v12, s[12:15], s88 offen offset:1024 sc1
    s_waitcnt lgkmcnt(0)
    v_mfma_f32_32x32x16_bf16 a[208:223], a[44:47], v[180:183], a[208:223]
    s_waitcnt vmcnt(9)
    v_mfma_f32_32x32x16_bf16 a[176:191], a[116:119], v[184:187], a[176:191]
    buffer_load_dwordx4 v[224:227], v12, s[12:15], s88 offen offset:2048 sc1
    v_mfma_f32_32x32x16_bf16 v[240:255], a[112:115], v[184:187], v[240:255]
    s_waitcnt vmcnt(9)
    v_mfma_f32_32x32x16_bf16 a[176:191], a[124:127], v[188:191], a[176:191]
    buffer_load_dwordx4 v[228:231], v12, s[12:15], s88 offen offset:3072 sc1
    v_mfma_f32_32x32x16_bf16 v[240:255], a[120:123], v[188:191], v[240:255]
    s_nop 0
    ds_write_b128 v26, a[192:195] offset:4096
    s_waitcnt vmcnt(9)
    v_mfma_f32_32x32x16_bf16 a[176:191], a[132:135], v[192:195], a[176:191]
    s_add_u32 s88, s88, 4096
    buffer_load_dwordx4 v[232:235], v12, s[12:15], s88 offen offset:0 sc1
    v_mfma_f32_32x32x16_bf16 v[240:255], a[128:131], v[192:195], v[240:255]
    ds_write_b128 v26, a[196:199] offset:5120
    s_waitcnt vmcnt(9)
    v_mfma_f32_32x32x16_bf16 a[176:191], a[140:143], v[196:199], a[176:191]
    buffer_load_dwordx4 v[236:239], v12, s[12:15], s88 offen offset:1024 sc1
    v_mfma_f32_32x32x16_bf16 v[240:255], a[136:139], v[196:199], v[240:255]
    ds_write_b128 v26, a[200:203] offset:6144
    s_waitcnt vmcnt(9)
    v_mfma_f32_32x32x16_bf16 a[176:191], a[148:151], v[200:203], a[176:191]
    buffer_load_dwordx2 v[112:113], v3, s[12:15], s56 offen sc1
    buffer_load_dwordx2 v[114:115], v28, s[12:15], s56 offen sc1
    buffer_load_dwordx2 v[116:117], v29, s[12:15], s56 offen sc1
    v_mfma_f32_32x32x16_bf16 v[240:255], a[144:147], v[200:203], v[240:255]
    ds_write_b128 v26, a[204:207] offset:7168
    s_waitcnt vmcnt(11)
    v_mfma_f32_32x32x16_bf16 a[176:191], a[156:159], v[204:207], a[176:191]
    buffer_load_dwordx2 v[118:119], v30, s[12:15], s56 offen sc1
    buffer_load_dwordx2 v[120:121], v31, s[12:15], s56 offen sc1
    buffer_load_dwordx2 v[122:123], v32, s[12:15], s56 offen sc1
    v_mfma_f32_32x32x16_bf16 v[240:255], a[152:155], v[204:207], v[240:255]
    ds_write_b128 v27, a[208:211] offset:8192
    s_waitcnt vmcnt(13)
    v_mfma_f32_32x32x16_bf16 a[176:191], a[164:167], v[208:211], a[176:191]
    buffer_load_dwordx2 v[124:125], v33, s[12:15], s56 offen sc1
    buffer_load_dwordx2 v[126:127], v34, s[12:15], s56 offen sc1
    buffer_load_dwordx2 v[20:21], v4, s[12:15], s57 offen sc1
    v_mfma_f32_32x32x16_bf16 v[240:255], a[160:163], v[208:211], v[240:255]
    ds_write_b128 v27, a[212:215] offset:9216
    s_waitcnt vmcnt(15)
    v_mfma_f32_32x32x16_bf16 a[176:191], a[172:175], v[212:215], a[176:191]
    v_mfma_f32_32x32x16_bf16 v[240:255], a[168:171], v[212:215], v[240:255]
    ds_write_b128 v27, a[216:219] offset:10240
    s_waitcnt vmcnt(14)
    v_mfma_f32_32x32x16_bf16 a[176:191], a[4:7], v[216:219], a[176:191]
    s_waitcnt vmcnt(13)
    v_mfma_f32_32x32x16_bf16 a[176:191], a[12:15], v[220:223], a[176:191]
    ds_write_b128 v27, a[220:223] offset:11264
    s_waitcnt vmcnt(12)
    v_mfma_f32_32x32x16_bf16 a[176:191], a[20:23], v[224:227], a[176:191]
    s_waitcnt vmcnt(11)
    v_mfma_f32_32x32x16_bf16 a[176:191], a[28:31], v[228:231], a[176:191]
    s_waitcnt vmcnt(10)
    v_mfma_f32_32x32x16_bf16 a[176:191], a[36:39], v[232:235], a[176:191]
    s_waitcnt vmcnt(9)
    v_mfma_f32_32x32x16_bf16 a[176:191], a[44:47], v[236:239], a[176:191]
    v_mfma_f32_32x32x16_bf16 v[240:255], a[0:3], v[216:219], v[240:255]
    v_mfma_f32_32x32x16_bf16 v[240:255], a[8:11], v[220:223], v[240:255]
    v_mfma_f32_32x32x16_bf16 v[240:255], a[16:19], v[224:227], v[240:255]
    s_nop 8
    ds_write_b128 v25, a[176:179] offset:0
    v_mfma_f32_32x32x16_bf16 v[240:255], a[24:27], v[228:231], v[240:255]
    ds_write_b128 v25, a[180:183] offset:1024
    v_mfma_f32_32x32x16_bf16 v[240:255], a[32:35], v[232:235], v[240:255]
    ds_write_b128 v25, a[184:187] offset:2048
    v_mfma_f32_32x32x16_bf16 v[240:255], a[40:43], v[236:239], v[240:255]
    ds_write_b128 v25, a[188:191] offset:3072
    s_waitcnt vmcnt(8)
    v_xor_b32 v113, v42, v113
    s_waitcnt vmcnt(7)
    v_xor_b32 v115, v42, v115
    s_waitcnt vmcnt(6)
    v_xor_b32 v117, v42, v117
    s_waitcnt vmcnt(5)
    v_xor_b32 v119, v42, v119
    s_waitcnt vmcnt(4)
    v_xor_b32 v121, v42, v121
    s_waitcnt vmcnt(3)
    v_xor_b32 v123, v42, v123
    s_waitcnt vmcnt(2)
    v_xor_b32 v125, v42, v125
    s_waitcnt vmcnt(1)
    v_xor_b32 v127, v42, v127
    s_waitcnt vmcnt(0)
    v_xor_b32 v21, v42, v21
    v_or3_b32 v113, v113, v115, v117
    v_or3_b32 v119, v119, v121, v123
    v_or3_b32 v125, v125, v127, v21
    v_or3_b32 v21, v113, v119, v125
    v_cmp_ne_u32 vcc, 0, v21
    s_cbranch_vccnz L_slow1
L_back1:
    s_waitcnt lgkmcnt(0)
    s_barrier
    ds_read_b128 v[64:67], v24 offset:0
    ds_read_b128 v[80:83], v24 offset:4096
    ds_read_b128 v[96:99], v24 offset:8192
    ds_read_b128 v[68:71], v24 offset:1024
    ds_read_b128 v[84:87], v24 offset:5120
    ds_read_b128 v[100:103], v24 offset:9216
    ds_read_b128 v[72:75], v24 offset:2048
    ds_read_b128 v[88:91], v24 offset:6144
    ds_read_b128 v[104:107], v24 offset:10240
    ds_read_b128 v[76:79], v24 offset:3072
    ds_read_b128 v[92:95], v24 offset:7168
    ds_read_b128 v[108:111], v24 offset:11264
    v_sub_f32 v46, 1.0, v20
    v_lshlrev_b32 v48, 16, v112
    v_and_b32 v49, 0xffff0000, v112
    v_lshlrev_b32 v50, 16, v114
    v_and_b32 v51, 0xffff0000, v114
    v_lshlrev_b32 v52, 16, v116
    v_and_b32 v53, 0xffff0000, v116
    v_lshlrev_b32 v54, 16, v118
    v_and_b32 v55, 0xffff0000, v118
    v_lshlrev_b32 v56, 16, v120
    v_and_b32 v57, 0xffff0000, v120
    v_lshlrev_b32 v58, 16, v122
    v_and_b32 v59, 0xffff0000, v122
    v_lshlrev_b32 v60, 16, v124
    v_and_b32 v61, 0xffff0000, v124
    v_lshlrev_b32 v62, 16, v126
    v_and_b32 v63, 0xffff0000, v126
    v_pk_mul_f32 v[48:49], v[48:49], v[20:21] op_sel_hi:[1,0]
    v_pk_mul_f32 v[50:51], v[50:51], v[20:21] op_sel_hi:[1,0]
    v_pk_mul_f32 v[52:53], v[52:53], v[20:21] op_sel_hi:[1,0]
    v_pk_mul_f32 v[54:55], v[54:55], v[20:21] op_sel_hi:[1,0]
    v_pk_mul_f32 v[56:57], v[56:57], v[20:21] op_sel_hi:[1,0]
    v_pk_mul_f32 v[58:59], v[58:59], v[20:21] op_sel_hi:[1,0]
    v_pk_mul_f32 v[60:61], v[60:61], v[20:21] op_sel_hi:[1,0]
    v_pk_mul_f32 v[62:63], v[62:63], v[20:21] op_sel_hi:[1,0]
    s_waitcnt lgkmcnt(11)
    v_pk_add_f32 v[240:241], v[240:241], v[64:65]
    s_waitcnt lgkmcnt(9)
    v_pk_add_f32 v[80:81], v[80:81], v[96:97]
    v_pk_add_f32 v[242:243], v[242:243], v[66:67]
    v_pk_add_f32 v[82:83], v[82:83], v[98:99]
    v_pk_add_f32 v[240:241], v[240:241], v[80:81]
    v_pk_add_f32 v[242:243], v[242:243], v[82:83]
    v_pk_fma_f32 v[240:241], v[240:241], v[46:47], v[48:49] op_sel_hi:[1,0,1]
    v_pk_fma_f32 v[242:243], v[242:243], v[46:47], v[50:51] op_sel_hi:[1,0,1]
    v_cvt_pk_bf16_f32 v120, v240, v241
    v_cvt_pk_bf16_f32 v121, v242, v243
    s_waitcnt lgkmcnt(8)
    v_pk_add_f32 v[244:245], v[244:245], v[68:69]
    s_waitcnt lgkmcnt(6)
    v_pk_add_f32 v[84:85], v[84:85], v[100:101]
    v_pk_add_f32 v[246:247], v[246:247], v[70:71]
    v_pk_add_f32 v[86:87], v[86:87], v[102:103]
    v_pk_add_f32 v[244:245], v[244:245], v[84:85]
    v_pk_add_f32 v[246:247], v[246:247], v[86:87]
    v_pk_fma_f32 v[244:245], v[244:245], v[46:47], v[52:53] op_sel_hi:[1,0,1]
    v_pk_fma_f32 v[246:247], v[246:247], v[46:47], v[54:55] op_sel_hi:[1,0,1]
    v_cvt_pk_bf16_f32 v122, v244, v245
    v_cvt_pk_bf16_f32 v123, v246, v247
    buffer_store_dwordx4 v[120:123], v5, s[20:23], s84 offen offset:0
    s_waitcnt lgkmcnt(5)
    v_pk_add_f32 v[248:249], v[248:249], v[72:73]
    s_waitcnt lgkmcnt(3)
    v_pk_add_f32 v[88:89], v[88:89], v[104:105]
    v_pk_add_f32 v[250:251], v[250:251], v[74:75]
    v_pk_add_f32 v[90:91], v[90:91], v[106:107]
    v_pk_add_f32 v[248:249], v[248:249], v[88:89]
    v_pk_add_f32 v[250:251], v[250:251], v[90:91]
    v_pk_fma_f32 v[248:249], v[248:249], v[46:47], v[56:57] op_sel_hi:[1,0,1]
    v_pk_fma_f32 v[250:251], v[250:251], v[46:47], v[58:59] op_sel_hi:[1,0,1]
    v_cvt_pk_bf16_f32 v124, v248, v249
    v_cvt_pk_bf16_f32 v125, v250, v251
    s_waitcnt lgkmcnt(2)
    v_pk_add_f32 v[252:253], v[252:253], v[76:77]
    s_waitcnt lgkmcnt(0)
    v_pk_add_f32 v[92:93], v[92:93], v[108:109]
    v_pk_add_f32 v[254:255], v[254:255], v[78:79]
    v_pk_add_f32 v[94:95], v[94:95], v[110:111]
    v_pk_add_f32 v[252:253], v[252:253], v[92:93]
    v_pk_add_f32 v[254:255], v[254:255], v[94:95]
    v_pk_fma_f32 v[252:253], v[252:253], v[46:47], v[60:61] op_sel_hi:[1,0,1]
    v_pk_fma_f32 v[254:255], v[254:255], v[46:47], v[62:63] op_sel_hi:[1,0,1]
    v_cvt_pk_bf16_f32 v126, v252, v253
    v_cvt_pk_bf16_f32 v127, v254, v255
    buffer_store_dwordx4 v[124:127], v5, s[20:23], s84 offen offset:16
L_end:
    s_endpgm
L_helper:
    s_mov_b32 s75, 0x40000000
    s_and_b32 s79, s2, 7
    s_lshl_b32 s79, s79, 2
    s_add_u32 s79, s79, s30
    s_sub_u32 s79, s79, 28
    s_lshl_b32 s80, s79, 2
    s_add_u32 s80, s80, s24
    s_mul_i32 s81, s80, 14336
    v_min_u32 v44, 55, v1
    v_lshl_add_u32 v44, v44, 7, s81
    s_barrier
    global_load_dword a255, v44, s[56:57]
    s_add_u32 s81, s81, 7168
    s_lshl_b32 s84, s79, 16
    s_lshl_b32 s68, s24, 14
    s_add_u32 s84, s84, s68
    s_mul_i32 s83, s24, 16640
    s_add_u32 s83, s83, 49152
    s_mov_b32 s82, s83
    s_branch L_hjoin
L_helper1:
    v_min_u32 v44, 55, v1
    v_lshl_add_u32 v44, v44, 7, s81
    s_waitcnt vmcnt(2)
    v_mul_f32 v48, 0x3fb8aa3b, v48
    v_mul_f32 v52, 0x3fb8aa3b, v52
    v_exp_f32 v52, v52
    v_exp_f32 v48, v48
    s_nop 0
    v_cvt_pk_bf16_f32 v53, v52, v48
    v_lshlrev_b32 v52, 16, v53
    v_and_b32 v48, 0xffff0000, v53
    v_mul_f32 v48, v48, v52
    v_mul_f32 v49, v49, v52
    v_mul_f32 v48, 0xbfb8aa3b, v48
    v_mul_f32 v49, 0x3e22f983, v49
    v_add_f32 v52, v52, v52
    v_mul_f32 v56, 0x41000000, v48
    v_mul_f32 v57, 0x41000000, v49
    v_exp_f32 v56, v56
    v_fract_f32 v57, v57
    v_mul_f32 v60, 0x43800000, v48
    v_cos_f32 v58, v57
    v_sin_f32 v59, v57
    v_mul_f32 v61, 0x43800000, v49
    v_mul_f32 v68, v56, v58
    v_mul_f32 v69, v56, v59
    v_exp_f32 v60, v60
    v_fract_f32 v61, v61
    v_exp_f32 v48, v48
    v_fract_f32 v49, v49
    v_cos_f32 v62, v61
    v_sin_f32 v63, v61
    v_cos_f32 v54, v49
    v_sin_f32 v55, v49
    v_mul_f32 v64, v50, v52
    v_mul_f32 v65, v51, v52
    v_mul_f32 v70, v60, v62
    v_mul_f32 v71, v60, v63
    v_mul_f32 v66, v48, v54
    v_mul_f32 v67, v48, v55
    .p2align 3
    v_mov_b32 v48, 0x3f80
    v_cvt_pk_bf16_f32 v49, v68, v69
    v_pk_mul_f32 v[128:129], v[68:69], v[68:69] op_sel:[0,0] op_sel_hi:[1,0]
    v_pk_fma_f32 v[128:129], v[68:69], v[68:69], v[128:129] op_sel:[1,1,0] op_sel_hi:[0,1,1] neg_lo:[1,0,0]
    v_cvt_pk_bf16_f32 v50, v128, v129
    v_pk_mul_f32 v[130:131], v[128:129], v[68:69] op_sel:[0,0] op_sel_hi:[1,0]
    v_pk_fma_f32 v[130:131], v[128:129], v[68:69], v[130:131] op_sel:[1,1,0] op_sel_hi:[0,1,1] neg_lo:[1,0,0]
    v_cvt_pk_bf16_f32 v51, v130, v131
    v_pk_mul_f32 v[128:129], v[130:131], v[68:69] op_sel:[0,0] op_sel_hi:[1,0]
    v_pk_fma_f32 v[128:129], v[130:131], v[68:69], v[128:129] op_sel:[1,1,0] op_sel_hi:[0,1,1] neg_lo:[1,0,0]
    v_cvt_pk_bf16_f32 v52, v128, v129
    v_pk_mul_f32 v[130:131], v[128:129], v[68:69] op_sel:[0,0] op_sel_hi:[1,0]
    v_pk_fma_f32 v[130:131], v[128:129], v[68:69], v[130:131] op_sel:[1,1,0] op_sel_hi:[0,1,1] neg_lo:[1,0,0]
    v_cvt_pk_bf16_f32 v53, v130, v131
    v_pk_mul_f32 v[128:129], v[130:131], v[68:69] op_sel:[0,0] op_sel_hi:[1,0]
    v_pk_fma_f32 v[128:129], v[130:131], v[68:69], v[128:129] op_sel:[1,1,0] op_sel_hi:[0,1,1] neg_lo:[1,0,0]
    v_cvt_pk_bf16_f32 v54, v128, v129
    v_pk_mul_f32 v[130:131], v[128:129], v[68:69] op_sel:[0,0] op_sel_hi:[1,0]
    v_pk_fma_f32 v[130:131], v[128:129], v[68:69], v[130:131] op_sel:[1,1,0] op_sel_hi:[0,1,1] neg_lo:[1,0,0]
    v_cvt_pk_bf16_f32 v55, v130, v131
    s_mov_b32 m0, s76
    s_nop 0
    ds_write_addtid_b32 v48 offset:0
    ds_write_addtid_b32 v49 offset:272
    ds_write_addtid_b32 v50 offset:544
    ds_write_addtid_b32 v51 offset:816
    ds_write_addtid_b32 v52 offset:1088
    ds_write_addtid_b32 v53 offset:1360
    ds_write_addtid_b32 v54 offset:1632
    ds_write_addtid_b32 v55 offset:1904
    v_pk_mul_f32 v[128:129], v[130:131], v[68:69] op_sel:[0,0] op_sel_hi:[1,0]
    v_pk_fma_f32 v[128:129], v[130:131], v[68:69], v[128:129] op_sel:[1,1,0] op_sel_hi:[0,1,1] neg_lo:[1,0,0]
    v_cvt_pk_bf16_f32 v56, v128, v129
    v_pk_mul_f32 v[130:131], v[128:129], v[68:69] op_sel:[0,0] op_sel_hi:[1,0]
    v_pk_fma_f32 v[130:131], v[128:129], v[68:69], v[130:131] op_sel:[1,1,0] op_sel_hi:[0,1,1] neg_lo:[1,0,0]
    v_cvt_pk_bf16_f32 v57, v130, v131
    v_pk_mul_f32 v[128:129], v[130:131], v[68:69] op_sel:[0,0] op_sel_hi:[1,0]
    v_pk_fma_f32 v[128:129], v[130:131], v[68:69], v[128:129] op_sel:[1,1,0] op_sel_hi:[0,1,1] neg_lo:[1,0,0]
    v_cvt_pk_bf16_f32 v58, v128, v129
    v_pk_mul_f32 v[130:131], v[128:129], v[68:69] op_sel:[0,0] op_sel_hi:[1,0]
    v_pk_fma_f32 v[130:131], v[128:129], v[68:69], v[130:131] op_sel:[1,1,0] op_sel_hi:[0,1,1] neg_lo:[1,0,0]
    v_cvt_pk_bf16_f32 v59, v130, v131
    v_pk_mul_f32 v[128:129], v[130:131], v[68:69] op_sel:[0,0] op_sel_hi:[1,0]
    v_pk_fma_f32 v[128:129], v[130:131], v[68:69], v[128:129] op_sel:[1,1,0] op_sel_hi:[0,1,1] neg_lo:[1,0,0]
    v_cvt_pk_bf16_f32 v60, v128, v129
    v_pk_mul_f32 v[130:131], v[128:129], v[68:69] op_sel:[0,0] op_sel_hi:[1,0]
    v_pk_fma_f32 v[130:131], v[128:129], v[68:69], v[130:131] op_sel:[1,1,0] op_sel_hi:[0,1,1] neg_lo:[1,0,0]
    v_cvt_pk_bf16_f32 v61, v130, v131
    v_pk_mul_f32 v[128:129], v[130:131], v[68:69] op_sel:[0,0] op_sel_hi:[1,0]
    v_pk_fma_f32 v[128:129], v[130:131], v[68:69], v[128:129] op_sel:[1,1,0] op_sel_hi:[0,1,1] neg_lo:[1,0,0]
    v_cvt_pk_bf16_f32 v62, v128, v129
    v_pk_mul_f32 v[130:131], v[128:129], v[68:69] op_sel:[0,0] op_sel_hi:[1,0]
    v_pk_fma_f32 v[130:131], v[128:129], v[68:69], v[130:131] op_sel:[1,1,0] op_sel_hi:[0,1,1] neg_lo:[1,0,0]
    v_cvt_pk_bf16_f32 v63, v130, v131
    s_mov_b32 m0, s76
    s_nop 0
    ds_write_addtid_b32 v56 offset:2176
    ds_write_addtid_b32 v57 offset:2448
    ds_write_addtid_b32 v58 offset:2720
    ds_write_addtid_b32 v59 offset:2992
    ds_write_addtid_b32 v60 offset:3264
    ds_write_addtid_b32 v61 offset:3536
    ds_write_addtid_b32 v62 offset:3808
    ds_write_addtid_b32 v63 offset:4080
    v_pk_mul_f32 v[128:129], v[130:131], v[68:69] op_sel:[0,0] op_sel_hi:[1,0]
    v_pk_fma_f32 v[128:129], v[130:131], v[68:69], v[128:129] op_sel:[1,1,0] op_sel_hi:[0,1,1] neg_lo:[1,0,0]
    v_cvt_pk_bf16_f32 v48, v128, v129
    v_pk_mul_f32 v[130:131], v[128:129], v[68:69] op_sel:[0,0] op_sel_hi:[1,0]
    v_pk_fma_f32 v[130:131], v[128:129], v[68:69], v[130:131] op_sel:[1,1,0] op_sel_hi:[0,1,1] neg_lo:[1,0,0]
    v_cvt_pk_bf16_f32 v49, v130, v131
    v_pk_mul_f32 v[128:129], v[130:131], v[68:69] op_sel:[0,0] op_sel_hi:[1,0]
    v_pk_fma_f32 v[128:129], v[130:131], v[68:69], v[128:129] op_sel:[1,1,0] op_sel_hi:[0,1,1] neg_lo:[1,0,0]
    v_cvt_pk_bf16_f32 v50, v128, v129
    v_pk_mul_f32 v[130:131], v[128:129], v[68:69] op_sel:[0,0] op_sel_hi:[1,0]
    v_pk_fma_f32 v[130:131], v[128:129], v[68:69], v[130:131] op_sel:[1,1,0] op_sel_hi:[0,1,1] neg_lo:[1,0,0]
    v_cvt_pk_bf16_f32 v51, v130, v131
    v_pk_mul_f32 v[128:129], v[130:131], v[68:69] op_sel:[0,0] op_sel_hi:[1,0]
    v_pk_fma_f32 v[128:129], v[130:131], v[68:69], v[128:129] op_sel:[1,1,0] op_sel_hi:[0,1,1] neg_lo:[1,0,0]
    v_cvt_pk_bf16_f32 v52, v128, v129
    v_pk_mul_f32 v[130:131], v[128:129], v[68:69] op_sel:[0,0] op_sel_hi:[1,0]
    v_pk_fma_f32 v[130:131], v[128:129], v[68:69], v[130:131] op_sel:[1,1,0] op_sel_hi:[0,1,1] neg_lo:[1,0,0]
    v_cvt_pk_bf16_f32 v53, v130, v131
    v_pk_mul_f32 v[128:129], v[130:131], v[68:69] op_sel:[0,0] op_sel_hi:[1,0]
    v_pk_fma_f32 v[128:129], v[130:131], v[68:69], v[128:129] op_sel:[1,1,0] op_sel_hi:[0,1,1] neg_lo:[1,0,0]
    v_cvt_pk_bf16_f32 v54, v128, v129
    v_pk_mul_f32 v[130:131], v[128:129], v[68:69] op_sel:[0,0] op_sel_hi:[1,0]
    v_pk_fma_f32 v[130:131], v[128:129], v[68:69], v[130:131] op_sel:[1,1,0] op_sel_hi:[0,1,1] neg_lo:[1,0,0]
    v_cvt_pk_bf16_f32 v55, v130, v131
    s_mov_b32 m0, s76
    s_nop 0
    ds_write_addtid_b32 v48 offset:4352
    ds_write_addtid_b32 v49 offset:4624
    ds_write_addtid_b32 v50 offset:4896
    ds_write_addtid_b32 v51 offset:5168
    ds_write_addtid_b32 v52 offset:5440
    ds_write_addtid_b32 v53 offset:5712
    ds_write_addtid_b32 v54 offset:5984
    ds_write_addtid_b32 v55 offset:6256
    v_pk_mul_f32 v[128:129], v[130:131], v[68:69] op_sel:[0,0] op_sel_hi:[1,0]
    v_pk_fma_f32 v[128:129], v[130:131], v[68:69], v[128:129] op_sel:[1,1,0] op_sel_hi:[0,1,1] neg_lo:[1,0,0]
    v_cvt_pk_bf16_f32 v56, v128, v129
    v_pk_mul_f32 v[130:131], v[128:129], v[68:69] op_sel:[0,0] op_sel_hi:[1,0]
    v_pk_fma_f32 v[130:131], v[128:129], v[68:69], v[130:131] op_sel:[1,1,0] op_sel_hi:[0,1,1] neg_lo:[1,0,0]
    v_cvt_pk_bf16_f32 v57, v130, v131
    v_pk_mul_f32 v[128:129], v[130:131], v[68:69] op_sel:[0,0] op_sel_hi:[1,0]
    v_pk_fma_f32 v[128:129], v[130:131], v[68:69], v[128:129] op_sel:[1,1,0] op_sel_hi:[0,1,1] neg_lo:[1,0,0]
    v_cvt_pk_bf16_f32 v58, v128, v129
    v_pk_mul_f32 v[130:131], v[128:129], v[68:69] op_sel:[0,0] op_sel_hi:[1,0]
    v_pk_fma_f32 v[130:131], v[128:129], v[68:69], v[130:131] op_sel:[1,1,0] op_sel_hi:[0,1,1] neg_lo:[1,0,0]
    v_cvt_pk_bf16_f32 v59, v130, v131
    v_pk_mul_f32 v[128:129], v[130:131], v[68:69] op_sel:[0,0] op_sel_hi:[1,0]
    v_pk_fma_f32 v[128:129], v[130:131], v[68:69], v[128:129] op_sel:[1,1,0] op_sel_hi:[0,1,1] neg_lo:[1,0,0]
    v_cvt_pk_bf16_f32 v60, v128, v129
    v_pk_mul_f32 v[130:131], v[128:129], v[68:69] op_sel:[0,0] op_sel_hi:[1,0]
    v_pk_fma_f32 v[130:131], v[128:129], v[68:69], v[130:131] op_sel:[1,1,0] op_sel_hi:[0,1,1] neg_lo:[1,0,0]
    v_cvt_pk_bf16_f32 v61, v130, v131
    v_pk_mul_f32 v[128:129], v[130:131], v[68:69] op_sel:[0,0] op_sel_hi:[1,0]
    v_pk_fma_f32 v[128:129], v[130:131], v[68:69], v[128:129] op_sel:[1,1,0] op_sel_hi:[0,1,1] neg_lo:[1,0,0]
    v_cvt_pk_bf16_f32 v62, v128, v129
    v_pk_mul_f32 v[130:131], v[128:129], v[68:69] op_sel:[0,0] op_sel_hi:[1,0]
    v_pk_fma_f32 v[130:131], v[128:129], v[68:69], v[130:131] op_sel:[1,1,0] op_sel_hi:[0,1,1] neg_lo:[1,0,0]
    v_cvt_pk_bf16_f32 v63, v130, v131
    s_mov_b32 m0, s76
    s_nop 0
    ds_write_addtid_b32 v56 offset:6528
    ds_write_addtid_b32 v57 offset:6800
    ds_write_addtid_b32 v58 offset:7072
    ds_write_addtid_b32 v59 offset:7344
    ds_write_addtid_b32 v60 offset:7616
    ds_write_addtid_b32 v61 offset:7888
    ds_write_addtid_b32 v62 offset:8160
    ds_write_addtid_b32 v63 offset:8432
    ds_read_b128 a[112:115], v15 offset:0
    ds_read_b128 a[116:119], v15 offset:32
    ds_read_b128 a[120:123], v15 offset:64
    ds_read_b128 a[124:127], v15 offset:96
    ds_read_b128 a[128:131], v15 offset:128
    ds_read_b128 a[132:135], v15 offset:160
    ds_read_b128 a[136:139], v15 offset:192
    ds_read_b128 a[140:143], v15 offset:224
    v_cvt_pk_bf16_f32 v48, v64, -v65
    v_pk_mul_f32 v[132:133], v[64:65], v[66:67] op_sel:[0,0] op_sel_hi:[1,0]
    v_pk_fma_f32 v[132:133], v[64:65], v[66:67], v[132:133] op_sel:[1,1,0] op_sel_hi:[0,1,1] neg_lo:[1,0,0]
    v_cvt_pk_bf16_f32 v49, v132, -v133
    v_pk_mul_f32 v[134:135], v[132:133], v[66:67] op_sel:[0,0] op_sel_hi:[1,0]
    v_pk_fma_f32 v[134:135], v[132:133], v[66:67], v[134:135] op_sel:[1,1,0] op_sel_hi:[0,1,1] neg_lo:[1,0,0]
    v_cvt_pk_bf16_f32 v50, v134, -v135
    v_pk_mul_f32 v[136:137], v[134:135], v[66:67] op_sel:[0,0] op_sel_hi:[1,0]
    v_pk_fma_f32 v[136:137], v[134:135], v[66:67], v[136:137] op_sel:[1,1,0] op_sel_hi:[0,1,1] neg_lo:[1,0,0]
    v_cvt_pk_bf16_f32 v51, v136, -v137
    v_pk_mul_f32 v[138:139], v[136:137], v[66:67] op_sel:[0,0] op_sel_hi:[1,0]
    v_pk_fma_f32 v[138:139], v[136:137], v[66:67], v[138:139] op_sel:[1,1,0] op_sel_hi:[0,1,1] neg_lo:[1,0,0]
    v_cvt_pk_bf16_f32 v52, v138, -v139
    v_pk_mul_f32 v[140:141], v[138:139], v[66:67] op_sel:[0,0] op_sel_hi:[1,0]
    v_pk_fma_f32 v[140:141], v[138:139], v[66:67], v[140:141] op_sel:[1,1,0] op_sel_hi:[0,1,1] neg_lo:[1,0,0]
    v_cvt_pk_bf16_f32 v53, v140, -v141
    v_pk_mul_f32 v[142:143], v[140:141], v[66:67] op_sel:[0,0] op_sel_hi:[1,0]
    v_pk_fma_f32 v[142:143], v[140:141], v[66:67], v[142:143] op_sel:[1,1,0] op_sel_hi:[0,1,1] neg_lo:[1,0,0]
    v_cvt_pk_bf16_f32 v54, v142, -v143
    s_mov_b32 m0, s76
    s_nop 0
    ds_write_addtid_b32 v48 offset:0
    ds_write_addtid_b32 v49 offset:272
    ds_write_addtid_b32 v50 offset:544
    ds_write_addtid_b32 v51 offset:816
    ds_write_addtid_b32 v52 offset:1088
    ds_write_addtid_b32 v53 offset:1360
    ds_write_addtid_b32 v54 offset:1632
    v_pk_mul_f32 v[144:145], v[142:143], v[66:67] op_sel:[0,0] op_sel_hi:[1,0]
    v_pk_fma_f32 v[144:145], v[142:143], v[66:67], v[144:145] op_sel:[1,1,0] op_sel_hi:[0,1,1] neg_lo:[1,0,0]
    v_cvt_pk_bf16_f32 v56, v144, -v145
    v_pk_mul_f32 v[146:147], v[144:145], v[66:67] op_sel:[0,0] op_sel_hi:[1,0]
    v_pk_fma_f32 v[146:147], v[144:145], v[66:67], v[146:147] op_sel:[1,1,0] op_sel_hi:[0,1,1] neg_lo:[1,0,0]
    v_pk_mul_f32 v[148:149], v[64:65], v[70:71] op_sel:[0,0] op_sel_hi:[1,0]
    v_pk_fma_f32 v[148:149], v[64:65], v[70:71], v[148:149] op_sel:[1,1,0] op_sel_hi:[0,1,1] neg_lo:[1,0,0]
    v_cvt_pk_bf16_f32 v57, v148, -v149
    v_pk_mul_f32 v[150:151], v[134:135], v[70:71] op_sel:[0,0] op_sel_hi:[1,0]
    v_pk_fma_f32 v[150:151], v[134:135], v[70:71], v[150:151] op_sel:[1,1,0] op_sel_hi:[0,1,1] neg_lo:[1,0,0]
    v_cvt_pk_bf16_f32 v58, v150, -v151
    v_pk_mul_f32 v[152:153], v[138:139], v[70:71] op_sel:[0,0] op_sel_hi:[1,0]
    v_pk_fma_f32 v[152:153], v[138:139], v[70:71], v[152:153] op_sel:[1,1,0] op_sel_hi:[0,1,1] neg_lo:[1,0,0]
    v_cvt_pk_bf16_f32 v59, v152, -v153
    v_pk_mul_f32 v[154:155], v[142:143], v[70:71] op_sel:[0,0] op_sel_hi:[1,0]
    v_pk_fma_f32 v[154:155], v[142:143], v[70:71], v[154:155] op_sel:[1,1,0] op_sel_hi:[0,1,1] neg_lo:[1,0,0]
    v_cvt_pk_bf16_f32 v60, v154, -v155
    v_pk_mul_f32 v[156:157], v[146:147], v[70:71] op_sel:[0,0] op_sel_hi:[1,0]
    v_pk_fma_f32 v[156:157], v[146:147], v[70:71], v[156:157] op_sel:[1,1,0] op_sel_hi:[0,1,1] neg_lo:[1,0,0]
    v_cvt_pk_bf16_f32 v61, v156, -v157
    v_pk_mul_f32 v[158:159], v[148:149], v[70:71] op_sel:[0,0] op_sel_hi:[1,0]
    v_pk_fma_f32 v[158:159], v[148:149], v[70:71], v[158:159] op_sel:[1,1,0] op_sel_hi:[0,1,1] neg_lo:[1,0,0]
    v_cvt_pk_bf16_f32 v62, v158, -v159
    s_mov_b32 m0, s76
    s_nop 0
    ds_write_addtid_b32 v56 offset:1904
    ds_write_addtid_b32 v57 offset:2176
    ds_write_addtid_b32 v58 offset:2448
    ds_write_addtid_b32 v59 offset:2720
    ds_write_addtid_b32 v59 offset:3264
    ds_write_addtid_b32 v60 offset:3536
    ds_write_addtid_b32 v61 offset:3808
    ds_write_addtid_b32 v62 offset:4352
    global_load_dword a253, v44, s[56:57]
    .p2align 3
    v_pk_mul_f32 v[160:161], v[152:153], v[70:71] op_sel:[0,0] op_sel_hi:[1,0]
    v_pk_fma_f32 v[160:161], v[152:153], v[70:71], v[160:161] op_sel:[1,1,0] op_sel_hi:[0,1,1] neg_lo:[1,0,0]
    v_cvt_pk_bf16_f32 v48, v160, -v161
    v_pk_mul_f32 v[162:163], v[156:157], v[70:71] op_sel:[0,0] op_sel_hi:[1,0]
    v_pk_fma_f32 v[162:163], v[156:157], v[70:71], v[162:163] op_sel:[1,1,0] op_sel_hi:[0,1,1] neg_lo:[1,0,0]
    v_cvt_pk_bf16_f32 v49, v162, -v163
    v_pk_mul_f32 v[164:165], v[158:159], v[70:71] op_sel:[0,0] op_sel_hi:[1,0]
    v_pk_fma_f32 v[164:165], v[158:159], v[70:71], v[164:165] op_sel:[1,1,0] op_sel_hi:[0,1,1] neg_lo:[1,0,0]
    v_cvt_pk_bf16_f32 v50, v164, -v165
    v_pk_mul_f32 v[166:167], v[160:161], v[70:71] op_sel:[0,0] op_sel_hi:[1,0]
    v_pk_fma_f32 v[166:167], v[160:161], v[70:71], v[166:167] op_sel:[1,1,0] op_sel_hi:[0,1,1] neg_lo:[1,0,0]
    v_cvt_pk_bf16_f32 v51, v166, -v167
    v_pk_mul_f32 v[168:169], v[162:163], v[70:71] op_sel:[0,0] op_sel_hi:[1,0]
    v_pk_fma_f32 v[168:169], v[162:163], v[70:71], v[168:169] op_sel:[1,1,0] op_sel_hi:[0,1,1] neg_lo:[1,0,0]
    v_cvt_pk_bf16_f32 v52, v168, -v169
    v_pk_mul_f32 v[170:171], v[164:165], v[70:71] op_sel:[0,0] op_sel_hi:[1,0]
    v_pk_fma_f32 v[170:171], v[164:165], v[70:71], v[170:171] op_sel:[1,1,0] op_sel_hi:[0,1,1] neg_lo:[1,0,0]
    v_cvt_pk_bf16_f32 v53, v170, -v171
    v_pk_mul_f32 v[172:173], v[168:169], v[70:71] op_sel:[0,0] op_sel_hi:[1,0]
    v_pk_fma_f32 v[172:173], v[168:169], v[70:71], v[172:173] op_sel:[1,1,0] op_sel_hi:[0,1,1] neg_lo:[1,0,0]
    v_cvt_pk_bf16_f32 v54, v172, -v173
    s_mov_b32 m0, s76
    s_nop 0
    ds_write_addtid_b32 v48 offset:4624
    ds_write_addtid_b32 v49 offset:4896
    ds_write_addtid_b32 v50 offset:5440
    ds_write_addtid_b32 v51 offset:5712
    ds_write_addtid_b32 v52 offset:5984
    ds_write_addtid_b32 v53 offset:6528
    ds_write_addtid_b32 v54 offset:6800
    .p2align 3
    v_pk_mul_f32 v[174:175], v[170:171], v[70:71] op_sel:[0,0] op_sel_hi:[1,0]
    v_pk_fma_f32 v[174:175], v[170:171], v[70:71], v[174:175] op_sel:[1,1,0] op_sel_hi:[0,1,1] neg_lo:[1,0,0]
    v_cvt_pk_bf16_f32 v56, v174, -v175
    v_pk_mul_f32 v[176:177], v[172:173], v[70:71] op_sel:[0,0] op_sel_hi:[1,0]
    v_pk_fma_f32 v[176:177], v[172:173], v[70:71], v[176:177] op_sel:[1,1,0] op_sel_hi:[0,1,1] neg_lo:[1,0,0]
    v_cvt_pk_bf16_f32 v57, v176, -v177
    v_pk_mul_f32 v[178:179], v[174:175], v[70:71] op_sel:[0,0] op_sel_hi:[1,0]
    v_pk_fma_f32 v[178:179], v[174:175], v[70:71], v[178:179] op_sel:[1,1,0] op_sel_hi:[0,1,1] neg_lo:[1,0,0]
    v_cvt_pk_bf16_f32 v58, v178, -v179
    v_pk_mul_f32 v[180:181], v[176:177], v[70:71] op_sel:[0,0] op_sel_hi:[1,0]
    v_pk_fma_f32 v[180:181], v[176:177], v[70:71], v[180:181] op_sel:[1,1,0] op_sel_hi:[0,1,1] neg_lo:[1,0,0]
    v_cvt_pk_bf16_f32 v59, v180, -v181
    v_pk_mul_f32 v[182:183], v[178:179], v[70:71] op_sel:[0,0] op_sel_hi:[1,0]
    v_pk_fma_f32 v[182:183], v[178:179], v[70:71], v[182:183] op_sel:[1,1,0] op_sel_hi:[0,1,1] neg_lo:[1,0,0]
    v_cvt_pk_bf16_f32 v60, v182, -v183
    v_pk_mul_f32 v[184:185], v[180:181], v[70:71] op_sel:[0,0] op_sel_hi:[1,0]
    v_pk_fma_f32 v[184:185], v[180:181], v[70:71], v[184:185] op_sel:[1,1,0] op_sel_hi:[0,1,1] neg_lo:[1,0,0]
    v_cvt_pk_bf16_f32 v61, v184, -v185
    s_mov_b32 m0, s76
    s_nop 0
    ds_write_addtid_b32 v56 offset:7072
    ds_write_addtid_b32 v57 offset:7344
    ds_write_addtid_b32 v58 offset:7616
    ds_write_addtid_b32 v59 offset:7888
    ds_write_addtid_b32 v60 offset:8160
    ds_write_addtid_b32 v61 offset:8432
    ds_read_b128 a[144:147], v47 offset:0
    ds_read_b128 a[148:151], v47 offset:32
    ds_read_b128 a[152:155], v47 offset:64
    ds_read_b128 a[156:159], v47 offset:96
    ds_read_b128 a[160:163], v47 offset:128
    ds_read_b128 a[164:167], v47 offset:160
    ds_read_b128 a[168:171], v47 offset:192
    ds_read_b128 a[172:175], v47 offset:224
    .p2align 3
    s_waitcnt lgkmcnt(7)
    v_mfma_f32_32x32x16_bf16 v[112:127], a[144:147], a[112:115], 0
    s_mov_b32 m0, s83
    s_add_u32 s83, s83, 1040
    buffer_load_dwordx4 v38, s[4:7], s84 offen lds
    s_add_u32 s84, s84, 1024
    v_add_u32 v14, s36, v38
    v_add_u32 v10, s37, v38
    s_waitcnt lgkmcnt(6)
    v_mfma_f32_32x32x16_bf16 v[112:127], a[148:151], a[116:119], v[112:127]
    s_mov_b32 m0, s83
    s_add_u32 s83, s83, 1040
    buffer_load_dwordx4 v38, s[4:7], s84 offen lds
    s_add_u32 s84, s84, 1024
    v_lshl_add_u32 v12, v8, 4, s77
    v_lshl_add_u32 v13, v9, 3, v12
    s_waitcnt lgkmcnt(5)
    v_mfma_f32_32x32x16_bf16 v[112:127], a[152:155], a[120:123], v[112:127]
    s_mov_b32 m0, s83
    s_add_u32 s83, s83, 1040
    buffer_load_dwordx4 v38, s[4:7], s84 offen lds
    s_add_u32 s84, s84, 1024
    v_lshl_add_u32 v11, v9, 9, v12
    v_lshl_add_u32 v15, v9, 10, v12
    s_waitcnt lgkmcnt(4)
    v_mfma_f32_32x32x16_bf16 v[112:127], a[156:159], a[124:127], v[112:127]
    s_mov_b32 m0, s83
    s_add_u32 s83, s83, 1040
    buffer_load_dwordx4 v38, s[4:7], s84 offen lds
    s_add_u32 s84, s84, 1024
    v_cmp_eq_u32 vcc, 0, v1
    s_nop 0
    s_waitcnt lgkmcnt(3)
    v_mfma_f32_32x32x16_bf16 v[112:127], a[160:163], a[128:131], v[112:127]
    s_mov_b32 m0, s83
    s_add_u32 s83, s83, 1040
    buffer_load_dwordx4 v38, s[4:7], s84 offen lds
    s_add_u32 s84, s84, 1024
    v_and_b32 v12, 1, v1
    v_cndmask_b32 v46, 0, v46, vcc
    s_waitcnt lgkmcnt(2)
    v_mfma_f32_32x32x16_bf16 v[112:127], a[164:167], a[132:135], v[112:127]
    s_mov_b32 m0, s83
    s_add_u32 s83, s83, 1040
    buffer_load_dwordx4 v38, s[4:7], s84 offen lds
    s_add_u32 s84, s84, 1024
    v_cmp_eq_u32 vcc, 1, v12
    v_and_b32 v47, 15, v1
    s_waitcnt lgkmcnt(1)
    v_mfma_f32_32x32x16_bf16 v[112:127], a[168:171], a[136:139], v[112:127]
    v_lshl_add_u32 v47, v47, 2, s77
    s_waitcnt lgkmcnt(0)
    v_mfma_f32_32x32x16_bf16 v[112:127], a[172:175], a[140:143], v[112:127]
    s_nop 11
    ds_write_b128 v14, v[120:123] offset:0
    ds_write_b128 v14, v[124:127] offset:1024
    s_waitcnt lgkmcnt(0)
    s_barrier
    ds_read_b128 v[48:51], v10 offset:0
    ds_read_b128 v[52:55], v10 offset:1024
    s_mov_b32 m0, s83
    s_add_u32 s83, s83, 1040
    buffer_load_dwordx4 v38, s[4:7], s84 offen lds
    s_add_u32 s84, s84, 1024
    s_mov_b32 m0, s83
    s_add_u32 s83, s83, 1040
    buffer_load_dwordx4 v38, s[4:7], s84 offen lds
    s_add_u32 s84, s84, 1024
    s_waitcnt lgkmcnt(1)
    v_pk_add_f32 v[112:113], v[112:113], v[48:49]
    v_pk_add_f32 v[114:115], v[114:115], v[50:51]
    s_waitcnt lgkmcnt(0)
    v_pk_add_f32 v[116:117], v[116:117], v[52:53]
    v_pk_add_f32 v[118:119], v[118:119], v[54:55]
    s_cmp_lg_u32 s28, 0
    s_cbranch_scc1 L_koddh
    v_add_f32 v112, v112, v46
    v_cvt_pk_bf16_f32 v49, v114, v115
    v_cvt_pk_bf16_f32 v48, v112, v113
    v_cvt_pk_bf16_f32 v50, v116, v116
    v_cvt_pk_bf16_f32 v51, v117, v118
    ds_write_b64 v13, v[48:49] offset:64
    ds_write_b64 v13, v[50:51] offset:576
    ds_write_b32 v47, v40
    s_branch L_kdoneh
L_koddh:
    v_cvt_pk_bf16_f32 v52, v112, v112
    v_cvt_pk_bf16_f32 v53, v112, v113
    v_cvt_pk_bf16_f32 v54, v113, v113
    v_cvt_pk_bf16_f32 v55, v114, v114
    v_cndmask_b32 v12, v116, v117, vcc
    v_cvt_pk_bf16_f32 v56, v116, v116
    v_cvt_pk_bf16_f32 v57, v116, v116
    v_cvt_pk_bf16_f32 v58, v12, v117
    v_cvt_pk_bf16_f32 v59, v117, v117
    v_cndmask_b32 v12, v118, v119, vcc
    v_cvt_pk_bf16_f32 v60, v118, v118
    v_cvt_pk_bf16_f32 v61, v118, v118
    v_cvt_pk_bf16_f32 v62, v12, v119
    v_cvt_pk_bf16_f32 v63, v119, v119
    ds_write_b128 v11, v[52:55] offset:1088
    ds_write_b128 v15, v[56:59] offset:2112
    ds_write_b128 v15, v[60:63] offset:2624
L_kdoneh:
    s_mov_b32 m0, s83
    s_add_u32 s83, s83, 1040
    buffer_load_dwordx4 v38, s[4:7], s84 offen lds
    s_add_u32 s84, s84, 1024
    s_mov_b32 m0, s83
    s_add_u32 s83, s83, 1040
    buffer_load_dwordx4 v38, s[4:7], s84 offen lds
    s_add_u32 s84, s84, 1024
    s_mov_b32 m0, s83
    s_add_u32 s83, s83, 1040
    buffer_load_dwordx4 v38, s[4:7], s84 offen lds
    s_add_u32 s84, s84, 1024
    s_mov_b32 m0, s83
    s_add_u32 s83, s83, 1040
    buffer_load_dwordx4 v38, s[4:7], s84 offen lds
    s_add_u32 s84, s84, 1024
    s_mov_b32 m0, s83
    s_add_u32 s83, s83, 1040
    buffer_load_dwordx4 v38, s[4:7], s84 offen lds
    s_add_u32 s84, s84, 1024
    s_mov_b32 m0, s83
    s_add_u32 s83, s83, 1040
    buffer_load_dwordx4 v38, s[4:7], s84 offen lds
    s_add_u32 s84, s84, 1024
    s_mov_b32 m0, s83
    s_add_u32 s83, s83, 1040
    buffer_load_dwordx4 v38, s[4:7], s84 offen lds
    s_add_u32 s84, s84, 1024
    s_mov_b32 m0, s83
    s_add_u32 s83, s83, 1040
    buffer_load_dwordx4 v38, s[4:7], s84 offen lds
    s_add_u32 s84, s84, 1024
    global_load_dwordx4 v[124:127], v38, s[58:59]
    global_load_dword v41, v40, s[62:63] sc1
    v_add_u32 v14, s82, v38
    v_mov_b32 v12, 0x40000000
    v_cmp_eq_u32 vcc, 0, v0
    s_lshl_b32 s86, s79, 7
    s_add_u32 s86, s86, 15859712
    v_cndmask_b32 v13, v12, 0, vcc
    v_lshl_add_u32 v10, v4, 2, v5
    v_mul_u32_u24 v10, 1040, v10
    v_lshl_add_u32 v10, v3, 3, v10
    s_lshl_b32 s68, s24, 8
    s_add_u32 s68, s68, 49152
    v_add_u32 v45, s68, v10
    s_lshl_b32 s81, s80, 14
    s_add_u32 s81, s81, 9437184
    s_waitcnt vmcnt(0)
    v_readfirstlane_b32 s35, v41
    s_nop 0
    s_cmp_eq_u32 s35, 0
    s_cbranch_scc1 L_slown1
L_backn1:
    v_mov_b32 v42, s35
    s_barrier
    ds_read_b64_tr_b16 v[128:129], v45 offset:0
    ds_read_b64_tr_b16 v[130:131], v45 offset:16640
    ds_read_b64_tr_b16 v[132:133], v45 offset:33280
    ds_read_b64_tr_b16 v[134:135], v45 offset:49920
    ds_read_b64_tr_b16 v[136:137], v45 offset:32
    ds_read_b64_tr_b16 v[138:139], v45 offset:16672
    ds_read_b64_tr_b16 v[140:141], v45 offset:33312
    ds_read_b64_tr_b16 v[142:143], v45 offset:49952
    ds_read_b64_tr_b16 v[144:145], v45 offset:64
    ds_read_b64_tr_b16 v[146:147], v45 offset:16704
    ds_read_b64_tr_b16 v[148:149], v45 offset:33344
    ds_read_b64_tr_b16 v[150:151], v45 offset:49984
    ds_read_b64_tr_b16 v[152:153], v45 offset:96
    ds_read_b64_tr_b16 v[154:155], v45 offset:16736
    ds_read_b64_tr_b16 v[156:157], v45 offset:33376
    ds_read_b64_tr_b16 v[158:159], v45 offset:50016
    ds_read_b64_tr_b16 v[160:161], v45 offset:128
    ds_read_b64_tr_b16 v[162:163], v45 offset:16768
    ds_read_b64_tr_b16 v[164:165], v45 offset:33408
    ds_read_b64_tr_b16 v[166:167], v45 offset:50048
    ds_read_b64_tr_b16 v[168:169], v45 offset:160
    ds_read_b64_tr_b16 v[170:171], v45 offset:16800
    ds_read_b64_tr_b16 v[172:173], v45 offset:33440
    ds_read_b64_tr_b16 v[174:175], v45 offset:50080
    ds_read_b64_tr_b16 v[176:177], v45 offset:192
    ds_read_b64_tr_b16 v[178:179], v45 offset:16832
    ds_read_b64_tr_b16 v[180:181], v45 offset:33472
    ds_read_b64_tr_b16 v[182:183], v45 offset:50112
    ds_read_b64_tr_b16 v[184:185], v45 offset:224
    ds_read_b64_tr_b16 v[186:187], v45 offset:16864
    ds_read_b64_tr_b16 v[188:189], v45 offset:33504
    ds_read_b64_tr_b16 v[190:191], v45 offset:50144
    ds_read_b128 v[192:195], v14 offset:0
    ds_read_b128 v[196:199], v14 offset:1040
    ds_read_b128 v[200:203], v14 offset:2080
    ds_read_b128 v[204:207], v14 offset:3120
    ds_read_b128 v[208:211], v14 offset:4160
    ds_read_b128 v[212:215], v14 offset:5200
    ds_read_b128 v[216:219], v14 offset:6240
    ds_read_b128 v[220:223], v14 offset:7280
    ds_read_b128 v[224:227], v14 offset:8320
    ds_read_b128 v[228:231], v14 offset:9360
    ds_read_b128 v[232:235], v14 offset:10400
    ds_read_b128 v[236:239], v14 offset:11440
    ds_read_b128 v[240:243], v14 offset:12480
    ds_read_b128 v[244:247], v14 offset:13520
    ds_read_b128 v[248:251], v14 offset:14560
    ds_read_b128 v[252:255], v14 offset:15600
    s_waitcnt lgkmcnt(15)
    buffer_store_dwordx4 v[128:131], v38, s[12:15], s81 offen offset:0 sc1
    buffer_store_dwordx4 v[132:135], v38, s[12:15], s81 offen offset:1024 sc1
    buffer_store_dwordx4 v[136:139], v38, s[12:15], s81 offen offset:2048 sc1
    buffer_store_dwordx4 v[140:143], v38, s[12:15], s81 offen offset:3072 sc1
    s_add_u32 s81, s81, 4096
    buffer_store_dwordx4 v[144:147], v38, s[12:15], s81 offen offset:0 sc1
    buffer_store_dwordx4 v[148:151], v38, s[12:15], s81 offen offset:1024 sc1
    buffer_store_dwordx4 v[152:155], v38, s[12:15], s81 offen offset:2048 sc1
    v_mov_b32 v64, 0
    v_mov_b32 v65, 0
    v_mov_b32 v66, 0
    v_mov_b32 v67, 0
    v_mov_b32 v68, 0
    v_mov_b32 v69, 0
    v_mov_b32 v70, 0
    v_mov_b32 v71, 0
    buffer_store_dwordx4 v[156:159], v38, s[12:15], s81 offen offset:3072 sc1
    s_add_u32 s81, s81, 4096
    v_mov_b32 v72, 0
    v_mov_b32 v73, 0
    v_mov_b32 v74, 0
    v_mov_b32 v75, 0
    v_mov_b32 v76, 0
    v_mov_b32 v77, 0
    v_mov_b32 v78, 0
    v_mov_b32 v79, 0
    buffer_store_dwordx4 v[160:163], v38, s[12:15], s81 offen offset:0 sc1
    v_dot2_f32_bf16 v64, v192, v124, v64
    s_waitcnt lgkmcnt(14)
    v_dot2_f32_bf16 v65, v196, v124, v65
    s_waitcnt lgkmcnt(13)
    v_dot2_f32_bf16 v66, v200, v124, v66
    s_waitcnt lgkmcnt(12)
    v_dot2_f32_bf16 v67, v204, v124, v67
    s_waitcnt lgkmcnt(11)
    v_dot2_f32_bf16 v68, v208, v124, v68
    s_waitcnt lgkmcnt(10)
    v_dot2_f32_bf16 v69, v212, v124, v69
    s_waitcnt lgkmcnt(9)
    v_dot2_f32_bf16 v70, v216, v124, v70
    s_waitcnt lgkmcnt(8)
    v_dot2_f32_bf16 v71, v220, v124, v71
    buffer_store_dwordx4 v[164:167], v38, s[12:15], s81 offen offset:1024 sc1
    s_waitcnt lgkmcnt(7)
    v_dot2_f32_bf16 v72, v224, v124, v72
    s_waitcnt lgkmcnt(6)
    v_dot2_f32_bf16 v73, v228, v124, v73
    s_waitcnt lgkmcnt(5)
    v_dot2_f32_bf16 v74, v232, v124, v74
    s_waitcnt lgkmcnt(4)
    v_dot2_f32_bf16 v75, v236, v124, v75
    s_waitcnt lgkmcnt(3)
    v_dot2_f32_bf16 v76, v240, v124, v76
    s_waitcnt lgkmcnt(2)
    v_dot2_f32_bf16 v77, v244, v124, v77
    s_waitcnt lgkmcnt(1)
    v_dot2_f32_bf16 v78, v248, v124, v78
    s_waitcnt lgkmcnt(0)
    v_dot2_f32_bf16 v79, v252, v124, v79
    buffer_store_dwordx4 v[168:171], v38, s[12:15], s81 offen offset:2048 sc1
    v_dot2_f32_bf16 v64, v193, v125, v64
    v_dot2_f32_bf16 v65, v197, v125, v65
    v_dot2_f32_bf16 v66, v201, v125, v66
    v_dot2_f32_bf16 v67, v205, v125, v67
    v_dot2_f32_bf16 v68, v209, v125, v68
    v_dot2_f32_bf16 v69, v213, v125, v69
    v_dot2_f32_bf16 v70, v217, v125, v70
    v_dot2_f32_bf16 v71, v221, v125, v71
    buffer_store_dwordx4 v[172:175], v38, s[12:15], s81 offen offset:3072 sc1
    s_add_u32 s81, s81, 4096
    v_dot2_f32_bf16 v72, v225, v125, v72
    v_dot2_f32_bf16 v73, v229, v125, v73
    v_dot2_f32_bf16 v74, v233, v125, v74
    v_dot2_f32_bf16 v75, v237, v125, v75
    v_dot2_f32_bf16 v76, v241, v125, v76
    v_dot2_f32_bf16 v77, v245, v125, v77
    v_dot2_f32_bf16 v78, v249, v125, v78
    v_dot2_f32_bf16 v79, v253, v125, v79
    buffer_store_dwordx4 v[176:179], v38, s[12:15], s81 offen offset:0 sc1
    v_dot2_f32_bf16 v64, v194, v126, v64
    v_dot2_f32_bf16 v65, v198, v126, v65
    v_dot2_f32_bf16 v66, v202, v126, v66
    v_dot2_f32_bf16 v67, v206, v126, v67
    v_dot2_f32_bf16 v68, v210, v126, v68
    v_dot2_f32_bf16 v69, v214, v126, v69
    v_dot2_f32_bf16 v70, v218, v126, v70
    v_dot2_f32_bf16 v71, v222, v126, v71
    buffer_store_dwordx4 v[180:183], v38, s[12:15], s81 offen offset:1024 sc1
    v_dot2_f32_bf16 v72, v226, v126, v72
    v_dot2_f32_bf16 v73, v230, v126, v73
    v_dot2_f32_bf16 v74, v234, v126, v74
    v_dot2_f32_bf16 v75, v238, v126, v75
    v_dot2_f32_bf16 v76, v242, v126, v76
    v_dot2_f32_bf16 v77, v246, v126, v77
    v_dot2_f32_bf16 v78, v250, v126, v78
    v_dot2_f32_bf16 v79, v254, v126, v79
    buffer_store_dwordx4 v[184:187], v38, s[12:15], s81 offen offset:2048 sc1
    v_dot2_f32_bf16 v64, v195, v127, v64
    v_dot2_f32_bf16 v65, v199, v127, v65
    v_dot2_f32_bf16 v66, v203, v127, v66
    v_dot2_f32_bf16 v67, v207, v127, v67
    v_dot2_f32_bf16 v68, v211, v127, v68
    v_dot2_f32_bf16 v69, v215, v127, v69
    v_dot2_f32_bf16 v70, v219, v127, v70
    v_dot2_f32_bf16 v71, v223, v127, v71
    buffer_store_dwordx4 v[188:191], v38, s[12:15], s81 offen offset:3072 sc1
    s_add_u32 s81, s81, 4096
    v_dot2_f32_bf16 v72, v227, v127, v72
    v_dot2_f32_bf16 v73, v231, v127, v73
    v_dot2_f32_bf16 v74, v235, v127, v74
    v_dot2_f32_bf16 v75, v239, v127, v75
    v_dot2_f32_bf16 v76, v243, v127, v76
    v_dot2_f32_bf16 v77, v247, v127, v77
    v_dot2_f32_bf16 v78, v251, v127, v78
    v_dot2_f32_bf16 v79, v255, v127, v79
    v_add_f32_dpp v64, v64, v64 row_shr:1 row_mask:0xf bank_mask:0xf bound_ctrl:0
    v_add_f32_dpp v65, v65, v65 row_shr:1 row_mask:0xf bank_mask:0xf bound_ctrl:0
    v_add_f32_dpp v66, v66, v66 row_shr:1 row_mask:0xf bank_mask:0xf bound_ctrl:0
    v_add_f32_dpp v67, v67, v67 row_shr:1 row_mask:0xf bank_mask:0xf bound_ctrl:0
    v_add_f32_dpp v68, v68, v68 row_shr:1 row_mask:0xf bank_mask:0xf bound_ctrl:0
    v_add_f32_dpp v69, v69, v69 row_shr:1 row_mask:0xf bank_mask:0xf bound_ctrl:0
    v_add_f32_dpp v70, v70, v70 row_shr:1 row_mask:0xf bank_mask:0xf bound_ctrl:0
    v_add_f32_dpp v71, v71, v71 row_shr:1 row_mask:0xf bank_mask:0xf bound_ctrl:0
    v_add_f32_dpp v72, v72, v72 row_shr:1 row_mask:0xf bank_mask:0xf bound_ctrl:0
    v_add_f32_dpp v73, v73, v73 row_shr:1 row_mask:0xf bank_mask:0xf bound_ctrl:0
    v_add_f32_dpp v74, v74, v74 row_shr:1 row_mask:0xf bank_mask:0xf bound_ctrl:0
    v_add_f32_dpp v75, v75, v75 row_shr:1 row_mask:0xf bank_mask:0xf bound_ctrl:0
    v_add_f32_dpp v76, v76, v76 row_shr:1 row_mask:0xf bank_mask:0xf bound_ctrl:0
    v_add_f32_dpp v77, v77, v77 row_shr:1 row_mask:0xf bank_mask:0xf bound_ctrl:0
    v_add_f32_dpp v78, v78, v78 row_shr:1 row_mask:0xf bank_mask:0xf bound_ctrl:0
    v_add_f32_dpp v79, v79, v79 row_shr:1 row_mask:0xf bank_mask:0xf bound_ctrl:0
    v_add_f32_dpp v64, v64, v64 row_shr:2 row_mask:0xf bank_mask:0xf bound_ctrl:0
    v_add_f32_dpp v65, v65, v65 row_shr:2 row_mask:0xf bank_mask:0xf bound_ctrl:0
    v_add_f32_dpp v66, v66, v66 row_shr:2 row_mask:0xf bank_mask:0xf bound_ctrl:0
    v_add_f32_dpp v67, v67, v67 row_shr:2 row_mask:0xf bank_mask:0xf bound_ctrl:0
    v_add_f32_dpp v68, v68, v68 row_shr:2 row_mask:0xf bank_mask:0xf bound_ctrl:0
    v_add_f32_dpp v69, v69, v69 row_shr:2 row_mask:0xf bank_mask:0xf bound_ctrl:0
    v_add_f32_dpp v70, v70, v70 row_shr:2 row_mask:0xf bank_mask:0xf bound_ctrl:0
    v_add_f32_dpp v71, v71, v71 row_shr:2 row_mask:0xf bank_mask:0xf bound_ctrl:0
    v_add_f32_dpp v72, v72, v72 row_shr:2 row_mask:0xf bank_mask:0xf bound_ctrl:0
    v_add_f32_dpp v73, v73, v73 row_shr:2 row_mask:0xf bank_mask:0xf bound_ctrl:0
    v_add_f32_dpp v74, v74, v74 row_shr:2 row_mask:0xf bank_mask:0xf bound_ctrl:0
    v_add_f32_dpp v75, v75, v75 row_shr:2 row_mask:0xf bank_mask:0xf bound_ctrl:0
    v_add_f32_dpp v76, v76, v76 row_shr:2 row_mask:0xf bank_mask:0xf bound_ctrl:0
    v_add_f32_dpp v77, v77, v77 row_shr:2 row_mask:0xf bank_mask:0xf bound_ctrl:0
    v_add_f32_dpp v78, v78, v78 row_shr:2 row_mask:0xf bank_mask:0xf bound_ctrl:0
    v_add_f32_dpp v79, v79, v79 row_shr:2 row_mask:0xf bank_mask:0xf bound_ctrl:0
    v_add_f32_dpp v64, v64, v64 row_shr:4 row_mask:0xf bank_mask:0xf bound_ctrl:0
    v_add_f32_dpp v65, v65, v65 row_shr:4 row_mask:0xf bank_mask:0xf bound_ctrl:0
    v_add_f32_dpp v66, v66, v66 row_shr:4 row_mask:0xf bank_mask:0xf bound_ctrl:0
    v_add_f32_dpp v67, v67, v67 row_shr:4 row_mask:0xf bank_mask:0xf bound_ctrl:0
    v_add_f32_dpp v68, v68, v68 row_shr:4 row_mask:0xf bank_mask:0xf bound_ctrl:0
    v_add_f32_dpp v69, v69, v69 row_shr:4 row_mask:0xf bank_mask:0xf bound_ctrl:0
    v_add_f32_dpp v70, v70, v70 row_shr:4 row_mask:0xf bank_mask:0xf bound_ctrl:0
    v_add_f32_dpp v71, v71, v71 row_shr:4 row_mask:0xf bank_mask:0xf bound_ctrl:0
    v_add_f32_dpp v72, v72, v72 row_shr:4 row_mask:0xf bank_mask:0xf bound_ctrl:0
    v_add_f32_dpp v73, v73, v73 row_shr:4 row_mask:0xf bank_mask:0xf bound_ctrl:0
    v_add_f32_dpp v74, v74, v74 row_shr:4 row_mask:0xf bank_mask:0xf bound_ctrl:0
    v_add_f32_dpp v75, v75, v75 row_shr:4 row_mask:0xf bank_mask:0xf bound_ctrl:0
    v_add_f32_dpp v76, v76, v76 row_shr:4 row_mask:0xf bank_mask:0xf bound_ctrl:0
    v_add_f32_dpp v77, v77, v77 row_shr:4 row_mask:0xf bank_mask:0xf bound_ctrl:0
    v_add_f32_dpp v78, v78, v78 row_shr:4 row_mask:0xf bank_mask:0xf bound_ctrl:0
    v_add_f32_dpp v79, v79, v79 row_shr:4 row_mask:0xf bank_mask:0xf bound_ctrl:0
    v_add_f32_dpp v64, v64, v64 row_shr:8 row_mask:0xf bank_mask:0xf bound_ctrl:0
    v_add_f32_dpp v65, v65, v65 row_shr:8 row_mask:0xf bank_mask:0xf bound_ctrl:0
    v_add_f32_dpp v66, v66, v66 row_shr:8 row_mask:0xf bank_mask:0xf bound_ctrl:0
    v_add_f32_dpp v67, v67, v67 row_shr:8 row_mask:0xf bank_mask:0xf bound_ctrl:0
    v_add_f32_dpp v68, v68, v68 row_shr:8 row_mask:0xf bank_mask:0xf bound_ctrl:0
    v_add_f32_dpp v69, v69, v69 row_shr:8 row_mask:0xf bank_mask:0xf bound_ctrl:0
    v_add_f32_dpp v70, v70, v70 row_shr:8 row_mask:0xf bank_mask:0xf bound_ctrl:0
    v_add_f32_dpp v71, v71, v71 row_shr:8 row_mask:0xf bank_mask:0xf bound_ctrl:0
    v_add_f32_dpp v72, v72, v72 row_shr:8 row_mask:0xf bank_mask:0xf bound_ctrl:0
    v_add_f32_dpp v73, v73, v73 row_shr:8 row_mask:0xf bank_mask:0xf bound_ctrl:0
    v_add_f32_dpp v74, v74, v74 row_shr:8 row_mask:0xf bank_mask:0xf bound_ctrl:0
    v_add_f32_dpp v75, v75, v75 row_shr:8 row_mask:0xf bank_mask:0xf bound_ctrl:0
    v_add_f32_dpp v76, v76, v76 row_shr:8 row_mask:0xf bank_mask:0xf bound_ctrl:0
    v_add_f32_dpp v77, v77, v77 row_shr:8 row_mask:0xf bank_mask:0xf bound_ctrl:0
    v_add_f32_dpp v78, v78, v78 row_shr:8 row_mask:0xf bank_mask:0xf bound_ctrl:0
    v_add_f32_dpp v79, v79, v79 row_shr:8 row_mask:0xf bank_mask:0xf bound_ctrl:0
    v_add_f32_dpp v64, v64, v64 row_bcast:15 row_mask:0xa bank_mask:0xf
    v_add_f32_dpp v65, v65, v65 row_bcast:15 row_mask:0xa bank_mask:0xf
    v_add_f32_dpp v66, v66, v66 row_bcast:15 row_mask:0xa bank_mask:0xf
    v_add_f32_dpp v67, v67, v67 row_bcast:15 row_mask:0xa bank_mask:0xf
    v_add_f32_dpp v68, v68, v68 row_bcast:15 row_mask:0xa bank_mask:0xf
    v_add_f32_dpp v69, v69, v69 row_bcast:15 row_mask:0xa bank_mask:0xf
    v_add_f32_dpp v70, v70, v70 row_bcast:15 row_mask:0xa bank_mask:0xf
    v_add_f32_dpp v71, v71, v71 row_bcast:15 row_mask:0xa bank_mask:0xf
    v_add_f32_dpp v72, v72, v72 row_bcast:15 row_mask:0xa bank_mask:0xf
    v_add_f32_dpp v73, v73, v73 row_bcast:15 row_mask:0xa bank_mask:0xf
    v_add_f32_dpp v74, v74, v74 row_bcast:15 row_mask:0xa bank_mask:0xf
    v_add_f32_dpp v75, v75, v75 row_bcast:15 row_mask:0xa bank_mask:0xf
    v_add_f32_dpp v76, v76, v76 row_bcast:15 row_mask:0xa bank_mask:0xf
    v_add_f32_dpp v77, v77, v77 row_bcast:15 row_mask:0xa bank_mask:0xf
    v_add_f32_dpp v78, v78, v78 row_bcast:15 row_mask:0xa bank_mask:0xf
    v_add_f32_dpp v79, v79, v79 row_bcast:15 row_mask:0xa bank_mask:0xf
    v_add_f32_dpp v64, v64, v64 row_bcast:31 row_mask:0xc bank_mask:0xf
    v_add_f32_dpp v65, v65, v65 row_bcast:31 row_mask:0xc bank_mask:0xf
    v_add_f32_dpp v66, v66, v66 row_bcast:31 row_mask:0xc bank_mask:0xf
    v_add_f32_dpp v67, v67, v67 row_bcast:31 row_mask:0xc bank_mask:0xf
    v_add_f32_dpp v68, v68, v68 row_bcast:31 row_mask:0xc bank_mask:0xf
    v_add_f32_dpp v69, v69, v69 row_bcast:31 row_mask:0xc bank_mask:0xf
    v_add_f32_dpp v70, v70, v70 row_bcast:31 row_mask:0xc bank_mask:0xf
    v_add_f32_dpp v71, v71, v71 row_bcast:31 row_mask:0xc bank_mask:0xf
    v_add_f32_dpp v72, v72, v72 row_bcast:31 row_mask:0xc bank_mask:0xf
    v_add_f32_dpp v73, v73, v73 row_bcast:31 row_mask:0xc bank_mask:0xf
    v_add_f32_dpp v74, v74, v74 row_bcast:31 row_mask:0xc bank_mask:0xf
    v_add_f32_dpp v75, v75, v75 row_bcast:31 row_mask:0xc bank_mask:0xf
    v_add_f32_dpp v76, v76, v76 row_bcast:31 row_mask:0xc bank_mask:0xf
    v_add_f32_dpp v77, v77, v77 row_bcast:31 row_mask:0xc bank_mask:0xf
    v_add_f32_dpp v78, v78, v78 row_bcast:31 row_mask:0xc bank_mask:0xf
    v_add_f32_dpp v79, v79, v79 row_bcast:31 row_mask:0xc bank_mask:0xf
    s_waitcnt vmcnt(0) lgkmcnt(0)
    s_barrier
    buffer_store_dword v42, v13, s[12:15], s86 offen sc1
    v_mov_b32 v80, 0
    v_readlane_b32 s36, v64, 63
    v_readlane_b32 s37, v65, 63
    v_readlane_b32 s38, v66, 63
    v_readlane_b32 s39, v67, 63
    s_nop 0
    v_writelane_b32 v80, s36, 0
    v_writelane_b32 v80, s37, 1
    v_writelane_b32 v80, s38, 2
    v_writelane_b32 v80, s39, 3
    v_readlane_b32 s36, v68, 63
    v_readlane_b32 s37, v69, 63
    v_readlane_b32 s38, v70, 63
    v_readlane_b32 s39, v71, 63
    s_nop 0
    v_writelane_b32 v80, s36, 4
    v_writelane_b32 v80, s37, 5
    v_writelane_b32 v80, s38, 6
    v_writelane_b32 v80, s39, 7
    v_readlane_b32 s36, v72, 63
    v_readlane_b32 s37, v73, 63
    v_readlane_b32 s38, v74, 63
    v_readlane_b32 s39, v75, 63
    s_nop 0
    v_writelane_b32 v80, s36, 8
    v_writelane_b32 v80, s37, 9
    v_writelane_b32 v80, s38, 10
    v_writelane_b32 v80, s39, 11
    v_readlane_b32 s36, v76, 63
    v_readlane_b32 s37, v77, 63
    v_readlane_b32 s38, v78, 63
    v_readlane_b32 s39, v79, 63
    s_nop 0
    v_writelane_b32 v80, s36, 12
    v_writelane_b32 v80, s37, 13
    v_writelane_b32 v80, s38, 14
    v_writelane_b32 v80, s39, 15
    v_cvt_pk_bf16_f32 v80, v80, v80
    v_and_b32 v80, 0xffff0000, v80
    v_mul_f32 v80, 0xbfb8aa3b, v80
    v_exp_f32 v80, v80
    v_cmp_gt_u32 vcc, 16, v1
    v_add_f32 v80, 1.0, v80
    v_rcp_f32 v80, v80
    v_lshlrev_b32 v13, 3, v1
    v_mov_b32 v81, v42
    v_cvt_pk_bf16_f32 v80, v80, v80
    v_cndmask_b32 v13, v12, v13, vcc
    v_and_b32 v80, 0xffff0000, v80
    s_lshl_b32 s68, s80, 7
    s_add_u32 s68, s68, 15728640
    buffer_store_dwordx2 v[80:81], v13, s[12:15], s68 offen sc1
    s_mov_b32 s20, s60
    s_mov_b32 s21, s61
    s_mov_b32 s22, 0x200000
    s_mov_b32 s23, 0x20000
    s_lshl_b32 s41, s24, 10
    s_add_u32 s41, s41, 15859712
    s_lshl_b32 s79, s33, 6
    s_lshl_b32 s69, s29, 5
    s_add_u32 s79, s79, s69
    s_mov_b32 s16, s56
    s_mov_b32 s17, s57
    s_mov_b32 s18, 1835008
    s_mul_i32 s69, s24, 28
    s_xor_b32 s42, s34, s33
    s_and_b32 s42, s42, 1
    s_mul_i32 s42, s42, 14
    s_add_u32 s69, s69, s42
    s_lshl_b32 s80, s69, 14
    s_lshl_b32 s68, s34, 7
    s_add_u32 s80, s80, s68
    s_lshl_b32 s46, s42, 15
    s_lshl_b32 s42, s42, 11
    s_lshl_b32 s81, s24, 12
    v_bfe_u32 v14, v6, 1, 1
    v_lshlrev_b32 v14, 2, v14
    v_xor_b32 v14, v14, v7
    v_lshlrev_b32 v14, 4, v14
    v_lshl_add_u32 v60, v6, 10, v14
    v_add_u32 v61, 7168, v60
    v_add_u32 v62, 14336, v60
    v_add_u32 v63, 21504, v60
    v_and_b32 v14, 1, v3
    v_lshl_add_u32 v14, v14, 2, v5
    v_lshrrev_b32 v15, 1, v14
    v_and_b32 v14, 1, v14
    v_lshlrev_b32 v14, 5, v14
    v_lshl_add_u32 v14, v15, 3, v14
    v_lshl_add_u32 v15, v9, 3, v4
    v_lshl_add_u32 v14, v15, 7, v14
    v_lshrrev_b32 v15, 1, v4
    v_xor_b32 v15, s28, v15
    v_lshl_add_u32 v10, v15, 6, v14
    v_xor_b32 v11, 64, v10
    v_add_u32 v10, s81, v10
    v_add_u32 v11, s81, v11
    v_add_u32 v58, 0x10000, v10
    v_add_u32 v59, 0x10000, v11
    s_mul_i32 s88, s33, 224
    s_add_u32 s88, s88, s69
    s_lshl_b32 s88, s88, 10
    s_add_u32 s88, s88, 65536
    s_add_u32 s89, s88, 14336
    s_sub_u32 s89, s89, s42
    s_lshr_b32 s43, s87, 3
    s_lshl_b32 s43, s43, 11
    s_bfe_u32 s69, s87, 0x20001
    s_lshl_b32 s69, s69, 8
    s_add_u32 s43, s43, s69
    s_and_b32 s69, s87, 1
    s_lshl_b32 s69, s69, 5
    s_add_u32 s43, s43, s69
    s_lshl_b32 s69, s24, 19
    s_add_u32 s43, s43, s69
    s_add_u32 s43, s43, 9437184
    s_add_u32 s39, s43, 261120
    s_lshl_b32 s44, s24, 11
    s_add_u32 s44, s44, 148480
    v_bfe_u32 v14, v1, 1, 2
    v_lshlrev_b32 v14, 6, v14
    v_and_b32 v15, 1, v6
    v_lshl_add_u32 v14, v15, 10, v14
    v_lshl_add_u32 v14, v3, 16, v14
    v_and_b32 v15, 1, v1
    v_lshl_add_u32 v15, v15, 4, v14
    s_lshl_b32 s68, s28, 8
    s_sub_u32 s68, 147840, s68
    s_lshl_b32 s69, s29, 4
    s_add_u32 s68, s68, s69
    v_lshlrev_b32 v37, 5, v8
    v_lshl_add_u32 v37, v9, 7, v37
    v_add_u32 v37, s68, v37
    s_lshl_b32 s38, s24, 8
    s_add_u32 s38, s38, 147456
    s_lshl_b32 s69, s25, 1
    s_add_u32 s69, s69, s29
    s_mul_i32 s45, s69, 224
    s_lshl_b32 s68, s26, 1
    s_add_u32 s68, s68, s28
    s_mul_i32 s52, s68, 37
    s_lshr_b32 s52, s52, 8
    s_mul_i32 s52, s52, 100
    s_lshl_b32 s51, s69, 9
    s_add_u32 s51, s51, s52
    s_lshl_b32 s52, s68, 2
    s_add_u32 s51, s51, s52
    s_cmp_lg_u32 s75, 0
    s_cselect_b32 s51, 0x4000, s51
    s_add_u32 s51, s51, 15990784
    s_lshl_b32 s68, s68, 2
    s_add_u32 s45, s45, s68
    s_lshl_b32 s45, s45, 10
    s_add_u32 s45, s45, 65536
    s_add_u32 s45, s45, s75
    s_add_u32 s50, s45, 114688
    s_lshl_b32 s52, s33, 2
    s_add_u32 s52, s52, s24
    s_lshl_b32 s52, s52, 7
    s_add_u32 s52, s52, 15990784
    s_lshl_b32 s53, s24, 13
    s_add_u32 s53, s53, 114688
    s_lshl_b32 s54, s24, 10
    s_add_u32 s54, s54, 114688
    s_lshl_b32 s55, s87, 14
    s_lshl_b32 s69, s24, 11
    s_add_u32 s55, s55, s69
    s_add_u32 s55, s55, 11534336
    s_add_u32 s40, s55, 8192
    s_lshl_b32 s56, s34, 5
    s_lshl_b32 s68, s28, 4
    s_add_u32 s56, s56, s68
    s_lshl_b32 s56, s56, 14
    s_lshl_b32 s68, s79, 3
    s_add_u32 s56, s56, s68
    s_add_u32 s56, s56, 11534336
    s_lshl_b32 s57, s79, 3
    s_add_u32 s57, s57, 15728640
    s_lshl_b32 s84, s79, 10
    s_lshl_b32 s68, s34, 7
    s_add_u32 s84, s84, s68
    s_lshl_b32 s68, s28, 6
    s_add_u32 s84, s84, s68
    s_mov_b32 s48, 0xbfb8aa3b
    s_mov_b32 s49, 0xbfb8aa3b
    s_mul_i32 s68, s29, 114688
    s_sub_u32 s69, 114688, s68
    v_add_u32 v12, s68, v38
    v_add_u32 v13, s69, v38
    v_lshlrev_b32 v0, 7, v7
    v_lshlrev_b32 v3, 3, v8
    v_lshl_add_u32 v3, v9, 17, v3
    v_lshlrev_b32 v4, 3, v8
    v_lshlrev_b32 v5, 10, v8
    v_lshl_add_u32 v5, v9, 5, v5
    v_mov_b32 v6, 0x40000000
    ds_read_b64_tr_b16 a[112:113], v36 offset:32
    ds_read_b64_tr_b16 a[114:115], v36 offset:0
    ds_read_b64_tr_b16 a[116:117], v36 offset:288
    ds_read_b64_tr_b16 a[118:119], v36 offset:256
    ds_read_b64_tr_b16 a[120:121], v36 offset:544
    ds_read_b64_tr_b16 a[122:123], v36 offset:512
    ds_read_b64_tr_b16 a[124:125], v36 offset:800
    ds_read_b64_tr_b16 a[126:127], v36 offset:768
    ds_read_b64_tr_b16 a[128:129], v36 offset:1056
    ds_read_b64_tr_b16 a[130:131], v36 offset:1024
    ds_read_b64_tr_b16 a[132:133], v36 offset:1312
    ds_read_b64_tr_b16 a[134:135], v36 offset:1280
    ds_read_b64_tr_b16 a[136:137], v36 offset:1568
    ds_read_b64_tr_b16 a[138:139], v36 offset:1536
    ds_read_b64_tr_b16 a[140:141], v36 offset:1824
    ds_read_b64_tr_b16 a[142:143], v36 offset:1792
    ds_read_b64_tr_b16 a[144:145], v36 offset:2080
    ds_read_b64_tr_b16 a[146:147], v36 offset:2048
    ds_read_b64_tr_b16 a[148:149], v36 offset:2336
    ds_read_b64_tr_b16 a[150:151], v36 offset:2304
    ds_read_b64_tr_b16 a[152:153], v36 offset:2592
    ds_read_b64_tr_b16 a[154:155], v36 offset:2560
    ds_read_b64_tr_b16 a[156:157], v36 offset:2848
    ds_read_b64_tr_b16 a[158:159], v36 offset:2816
    ds_read_b64_tr_b16 a[160:161], v36 offset:3104
    ds_read_b64_tr_b16 a[162:163], v36 offset:3072
    ds_read_b64_tr_b16 a[164:165], v36 offset:3360
    ds_read_b64_tr_b16 a[166:167], v36 offset:3328
    ds_read_b64_tr_b16 a[168:169], v36 offset:3616
    ds_read_b64_tr_b16 a[170:171], v36 offset:3584
    ds_read_b64_tr_b16 a[172:173], v36 offset:3872
    ds_read_b64_tr_b16 a[174:175], v36 offset:3840
    s_waitcnt lgkmcnt(0)
    s_barrier
    s_add_u32 m0, s81, 0
    s_nop 0
    buffer_load_dwordx4 v60, s[16:19], s80 offen lds
    buffer_load_dwordx4 v61, s[16:19], s80 offen offset:1024 lds
    buffer_load_dwordx4 v62, s[16:19], s80 offen offset:2048 lds
    buffer_load_dwordx4 v63, s[16:19], s80 offen offset:3072 lds
    s_add_u32 s80, s80, 32768
    s_add_u32 m0, s81, 16384
    s_nop 0
    buffer_load_dwordx4 v60, s[16:19], s80 offen lds
    buffer_load_dwordx4 v61, s[16:19], s80 offen offset:1024 lds
    buffer_load_dwordx4 v62, s[16:19], s80 offen offset:2048 lds
    buffer_load_dwordx4 v63, s[16:19], s80 offen offset:3072 lds
    s_add_u32 s80, s80, 32768
    s_add_u32 m0, s81, 81920
    s_nop 0
    buffer_load_dwordx4 v60, s[16:19], s80 offen lds
    buffer_load_dwordx4 v61, s[16:19], s80 offen offset:1024 lds
    buffer_load_dwordx4 v62, s[16:19], s80 offen offset:2048 lds
    buffer_load_dwordx4 v63, s[16:19], s80 offen offset:3072 lds
    s_add_u32 s80, s80, 32768
    s_add_u32 m0, s81, 98304
    s_nop 0
    buffer_load_dwordx4 v60, s[16:19], s80 offen lds
    buffer_load_dwordx4 v61, s[16:19], s80 offen offset:1024 lds
    buffer_load_dwordx4 v62, s[16:19], s80 offen offset:2048 lds
    buffer_load_dwordx4 v63, s[16:19], s80 offen offset:3072 lds
    s_add_u32 s80, s80, 32768
    s_add_u32 m0, s81, 32768
    s_nop 0
    buffer_load_dwordx4 v60, s[16:19], s80 offen lds
    buffer_load_dwordx4 v61, s[16:19], s80 offen offset:1024 lds
    buffer_load_dwordx4 v62, s[16:19], s80 offen offset:2048 lds
    buffer_load_dwordx4 v63, s[16:19], s80 offen offset:3072 lds
    s_add_u32 s80, s80, 32768
    s_add_u32 m0, s81, 49152
    s_nop 0
    buffer_load_dwordx4 v60, s[16:19], s80 offen lds
    buffer_load_dwordx4 v61, s[16:19], s80 offen offset:1024 lds
    buffer_load_dwordx4 v62, s[16:19], s80 offen offset:2048 lds
    buffer_load_dwordx4 v63, s[16:19], s80 offen offset:3072 lds
    s_add_u32 s80, s80, 32768
    s_add_u32 m0, s81, 65536
    s_nop 0
    buffer_load_dwordx4 v60, s[16:19], s80 offen lds
    buffer_load_dwordx4 v61, s[16:19], s80 offen offset:1024 lds
    buffer_load_dwordx4 v62, s[16:19], s80 offen offset:2048 lds
    buffer_load_dwordx4 v63, s[16:19], s80 offen offset:3072 lds
    s_add_u32 s80, s80, 32768
    s_sub_u32 s80, s80, s46
    buffer_load_dword v44, v0, s[12:15], s41 offen sc1
    s_waitcnt vmcnt(25)
    ds_read_b64_tr_b16 a[0:1], v10 offset:0
    ds_read_b64_tr_b16 a[2:3], v10 offset:512
    ds_read_b64_tr_b16 a[4:5], v11 offset:0
    ds_read_b64_tr_b16 a[6:7], v11 offset:512
    ds_read_b64_tr_b16 a[8:9], v10 offset:2048
    ds_read_b64_tr_b16 a[10:11], v10 offset:2560
    ds_read_b64_tr_b16 a[12:13], v11 offset:2048
    ds_read_b64_tr_b16 a[14:15], v11 offset:2560
    s_waitcnt vmcnt(21)
    ds_read_b64_tr_b16 a[16:17], v10 offset:16384
    ds_read_b64_tr_b16 a[18:19], v10 offset:16896
    ds_read_b64_tr_b16 a[20:21], v11 offset:16384
    ds_read_b64_tr_b16 a[22:23], v11 offset:16896
    ds_read_b64_tr_b16 a[24:25], v10 offset:18432
    ds_read_b64_tr_b16 a[26:27], v10 offset:18944
    ds_read_b64_tr_b16 a[28:29], v11 offset:18432
    ds_read_b64_tr_b16 a[30:31], v11 offset:18944
    s_waitcnt vmcnt(17)
    ds_read_b64_tr_b16 a[32:33], v58 offset:16384
    ds_read_b64_tr_b16 a[34:35], v58 offset:16896
    ds_read_b64_tr_b16 a[36:37], v59 offset:16384
    ds_read_b64_tr_b16 a[38:39], v59 offset:16896
    ds_read_b64_tr_b16 a[40:41], v58 offset:18432
    ds_read_b64_tr_b16 a[42:43], v58 offset:18944
    ds_read_b64_tr_b16 a[44:45], v59 offset:18432
    ds_read_b64_tr_b16 a[46:47], v59 offset:18944
    s_waitcnt vmcnt(13)
    ds_read_b64_tr_b16 a[48:49], v58 offset:32768
    ds_read_b64_tr_b16 a[50:51], v58 offset:33280
    ds_read_b64_tr_b16 a[52:53], v59 offset:32768
    ds_read_b64_tr_b16 a[54:55], v59 offset:33280
    ds_read_b64_tr_b16 a[56:57], v58 offset:34816
    ds_read_b64_tr_b16 a[58:59], v58 offset:35328
    ds_read_b64_tr_b16 a[60:61], v59 offset:34816
    ds_read_b64_tr_b16 a[62:63], v59 offset:35328
    s_waitcnt vmcnt(0)
    v_cmp_ne_u32 vcc, s35, v44
    s_cbranch_vccnz L_slow2
L_back2:
    s_mov_b32 m0, s38
    s_nop 0
    buffer_load_dword v6, s[12:15], 0 offen lds
    s_mov_b32 m0, s44
    s_nop 0
    buffer_load_dwordx4 v15, s[12:15], s43 offen sc1 lds
    buffer_load_dwordx4 v15, s[12:15], s39 offen offset:1024 sc1 lds
    s_waitcnt vmcnt(0) lgkmcnt(0)
    s_barrier
    ds_read_b128 a[176:179], v37 offset:0
    ds_read_b128 a[180:183], v37 offset:512
    ds_read_b128 a[184:187], v37 offset:1024
    ds_read_b128 a[188:191], v37 offset:1536
    ds_read_b128 a[192:195], v37 offset:2048
    ds_read_b128 a[196:199], v37 offset:2560
    ds_read_b128 a[200:203], v37 offset:3072
    ds_read_b128 a[204:207], v37 offset:3584
    ds_read_b128 a[208:211], v37 offset:4096
    ds_read_b128 a[212:215], v37 offset:4608
    ds_read_b128 a[216:219], v37 offset:5120
    ds_read_b128 a[220:223], v37 offset:5632
    ds_read_b128 a[224:227], v37 offset:6144
    ds_read_b128 a[228:231], v37 offset:6656
    ds_read_b128 a[232:235], v37 offset:7168
    ds_read_b128 a[236:239], v37 offset:7680
    s_waitcnt vmcnt(0) lgkmcnt(0)
    s_barrier
    s_branch L_cjoin
L_slow0:
    s_mov_b32 s95, 0
L_slowloop0:
    s_sleep 2
    buffer_load_dword v44, v0, s[12:15], s41 offen sc1
    s_waitcnt vmcnt(0)
    s_add_u32 s95, s95, 1
    s_cmp_ge_u32 s95, 200000
    s_cbranch_scc1 L_back0
    v_cmp_ne_u32 vcc, s35, v44
    s_cbranch_vccnz L_slowloop0
    s_branch L_back0
L_slown0:
    s_mov_b32 s95, 0
L_slownloop0:
    global_load_dword v41, v40, s[62:63] sc1
    s_waitcnt vmcnt(0)
    v_readfirstlane_b32 s35, v41
    s_add_u32 s95, s95, 1
    s_cmp_ge_u32 s95, 200000
    s_cbranch_scc1 L_backn0
    s_cmp_eq_u32 s35, 0
    s_cbranch_scc1 L_slownloop0
    s_branch L_backn0
L_slowf2:
    s_mov_b32 s95, 0
L_slowf2loop:
    s_load_dwordx8 s[4:11], s[64:65], s52 glc
    s_waitcnt lgkmcnt(0)
    s_add_u32 s95, s95, 1
    s_cmp_ge_u32 s95, 200000
    s_cbranch_scc1 L_backf2
    s_xor_b32 s4, s4, s35
    s_xor_b32 s5, s5, s35
    s_xor_b32 s6, s6, s35
    s_xor_b32 s7, s7, s35
    s_xor_b32 s8, s8, s35
    s_xor_b32 s9, s9, s35
    s_xor_b32 s10, s10, s35
    s_or_b32 s4, s4, s5
    s_or_b32 s6, s6, s7
    s_or_b32 s8, s8, s9
    s_or_b32 s4, s4, s6
    s_or_b32 s8, s8, s10
    s_or_b32 s4, s4, s8
    s_cbranch_scc1 L_slowf2loop
    s_branch L_backf2
L_slow1:
    s_mov_b32 s95, 0
L_slowloop1:
    s_sleep 2
    buffer_load_dwordx2 v[112:113], v3, s[12:15], s56 offen sc1
    buffer_load_dwordx2 v[114:115], v28, s[12:15], s56 offen sc1
    buffer_load_dwordx2 v[116:117], v29, s[12:15], s56 offen sc1
    buffer_load_dwordx2 v[118:119], v30, s[12:15], s56 offen sc1
    buffer_load_dwordx2 v[120:121], v31, s[12:15], s56 offen sc1
    buffer_load_dwordx2 v[122:123], v32, s[12:15], s56 offen sc1
    buffer_load_dwordx2 v[124:125], v33, s[12:15], s56 offen sc1
    buffer_load_dwordx2 v[126:127], v34, s[12:15], s56 offen sc1
    buffer_load_dwordx2 v[20:21], v4, s[12:15], s57 offen sc1
    s_waitcnt vmcnt(0)
    v_xor_b32 v113, v42, v113
    v_xor_b32 v115, v42, v115
    v_xor_b32 v117, v42, v117
    v_xor_b32 v119, v42, v119
    v_xor_b32 v121, v42, v121
    v_xor_b32 v123, v42, v123
    v_xor_b32 v125, v42, v125
    v_xor_b32 v127, v42, v127
    v_xor_b32 v21, v42, v21
    v_or3_b32 v113, v113, v115, v117
    v_or3_b32 v119, v119, v121, v123
    v_or3_b32 v125, v125, v127, v21
    v_or3_b32 v21, v113, v119, v125
    s_add_u32 s95, s95, 1
    s_cmp_ge_u32 s95, 200000
    s_cbranch_scc1 L_back1
    v_cmp_ne_u32 vcc, 0, v21
    s_cbranch_vccnz L_slowloop1
    s_branch L_back1
L_slown1:
    s_mov_b32 s95, 0
L_slownloop1:
    global_load_dword v41, v40, s[62:63] sc1
    s_waitcnt vmcnt(0)
    v_readfirstlane_b32 s35, v41
    s_add_u32 s95, s95, 1
    s_cmp_ge_u32 s95, 200000
    s_cbranch_scc1 L_backn1
    s_cmp_eq_u32 s35, 0
    s_cbranch_scc1 L_slownloop1
    s_branch L_backn1
L_slow2:
    s_mov_b32 s95, 0
L_slowloop2:
    s_sleep 2
    buffer_load_dword v44, v0, s[12:15], s41 offen sc1
    s_waitcnt vmcnt(0)
    s_add_u32 s95, s95, 1
    s_cmp_ge_u32 s95, 200000
    s_cbranch_scc1 L_back2
    v_cmp_ne_u32 vcc, s35, v44
    s_cbranch_vccnz L_slowloop2
    s_branch L_back2
L_code_end:
    s_endpgm
.section .rodata,"a"
.p2align 6
.amdhsa_kernel gated_mix__ssm_conv_s4d__glu_gated_swiglu__prompt_kernel
  .amdhsa_next_free_vgpr 512
  .amdhsa_next_free_sgpr 102
  .amdhsa_accum_offset 256
  .amdhsa_group_segment_fixed_size 0
  .amdhsa_kernarg_size 120
  .amdhsa_user_sgpr_count 2
  .amdhsa_user_sgpr_kernarg_segment_ptr 1
  .amdhsa_system_sgpr_workgroup_id_x 1
.end_amdhsa_kernel
```
